```python
import torch

def _softmax(x, axis=-1):
    return torch.softmax(x, dim=axis)
def _gelu(x):
    return torch.nn.functional.gelu(x, approximate="tanh")
def _silu(x):
    return torch.nn.functional.silu(x)
def _sigmoid(x):
    return torch.sigmoid(x)
def _layernorm(x, axis=-1, eps=1e-5):
    m = x.mean(dim=axis, keepdim=True)
    v = x.var(dim=axis, keepdim=True, unbiased=False)
    return (x - m) / torch.sqrt(v + eps)
def _scatter_add(tgt, idx, src, axis=0):
    return tgt.clone().index_add_(axis, idx, src)
def _segment_sum(src, seg, n):
    out = torch.zeros((n,) + src.shape[1:], dtype=src.dtype)
    return out.index_add_(0, seg, src)
def _pad(x, pw):
    flat = tuple(v for pair in reversed(pw) for v in pair)
    return torch.nn.functional.pad(x, flat)

kernel_name = 'sequential_preLN__linear_attn_block__glu_gated_bilinear__prompt'

def setup_inputs():

    _w = (lambda a: (lambda t: t.to(torch.bfloat16) if t.is_floating_point() else t)(torch.as_tensor(a)))
    def _A_setup():
        B, S, D = 1, 2048, 448
        return {
            "x": _w((lambda *s: torch.randn(*s, dtype=torch.bfloat16) * 0.05)(B, S, D)),
            "wqkv": _w((lambda *s: torch.randn(*s, dtype=torch.bfloat16) * 0.1)(D, 3 * D)),
            "wo": _w((lambda *s: torch.randn(*s, dtype=torch.bfloat16) * 0.05)(D, D)),
        }
    _A_in = _A_setup()

    def _B_setup():
        B, S, D, F = 1, 2048, 448, 1792
        return {
            "x": _w((lambda *s: torch.randn(*s, dtype=torch.bfloat16) * 0.05)(B, S, D)),
            "w_gate": _w((lambda *s: torch.randn(*s, dtype=torch.bfloat16) * 0.4)(D, F) * (D ** -0.5)),
            "w_up": _w((lambda *s: torch.randn(*s, dtype=torch.bfloat16) * 0.4)(D, F) * (D ** -0.5)),
            "w_down": _w((lambda *s: torch.randn(*s, dtype=torch.bfloat16) * 0.4)(F, D) * (F ** -0.5)),
        }
    _B_in = _B_setup()

    return {
        "A_x": _A_in["x"],
        "A_wqkv": _A_in["wqkv"],
        "A_wo": _A_in["wo"],
        "B_x": _B_in["x"],
        "B_w_gate": _B_in["w_gate"],
        "B_w_up": _B_in["w_up"],
        "B_w_down": _B_in["w_down"],
    }

def reference(A_x, A_wqkv, A_wo, B_x, B_w_gate, B_w_up, B_w_down):
    def _A_ref(x, wqkv, wo):
        B, S, D = x.shape
        H = 16; Dh = D // H
        qkv = (lambda x, *d: x.permute(*d))((x @ wqkv).reshape(B, S, 3, H, Dh), 2, 0, 3, 1, 4)
        q, k, v = qkv[0], qkv[1], qkv[2]
        phi = lambda t: torch.where(t > 0, t + 1, torch.exp(t)) + 1e-6
        pq, pk = phi(q), phi(k)
        kv = torch.einsum("bhsd,bhse->bhde", pk, v)
        z = torch.einsum("bhsd->bhd", pk)
        num = torch.einsum("bhqd,bhde->bhqe", pq, kv)
        den = torch.einsum("bhqd,bhd->bhq", pq, z)[..., None] + 1e-6
        o = num / den
        return (lambda x, *d: x.permute(*d))(o, 0, 2, 1, 3).reshape(B, S, D) @ wo

    def _B_ref(x, w_gate, w_up, w_down):
        g = torch.einsum("bsd,df->bsf", x, w_gate)
        u = torch.einsum("bsd,df->bsf", x, w_up)
        h = g * u
        return torch.einsum("bsf,fd->bsd", h, w_down)

    x = A_x
    h = x + _A_ref(_layernorm(x, axis=-1), A_wqkv, A_wo)
    h2 = h + _B_ref(_layernorm(h, axis=-1), B_w_gate, B_w_up, B_w_down)
    return h2
```

```asm
; @launch grid=(256,1,1) block=(512,1,1) lds=163840
.amdgcn_target "amdgcn-amd-amdhsa--gfx950"
.text
.globl sequential_preLN__linear_attn_block__glu_gated_bilinear__prompt_kernel
.p2align 8
.type sequential_preLN__linear_attn_block__glu_gated_bilinear__prompt_kernel,@function
sequential_preLN__linear_attn_block__glu_gated_bilinear__prompt_kernel:
    s_cmp_ge_u32 s2, 256
    s_cbranch_scc1 .Lexit
    s_load_dwordx2 s[8:9], s[0:1], 0
    s_load_dwordx2 s[12:13], s[0:1], 8
    s_load_dwordx2 s[32:33], s[0:1], 72
    v_and_b32 v1, 63, v0
    v_lshrrev_b32 v6, 6, v0
    v_lshrrev_b32 v3, 4, v1
    v_readfirstlane_b32 s3, v6
    v_lshrrev_b32 v6, 3, v1
    v_and_b32 v7, 7, v1
    v_mul_u32_u24 v8, 896, v6
    v_xor_b32 v9, v7, v3
    v_lshl_add_u32 v26, v9, 4, v8
    s_and_b32 s36, s2, 7
    s_lshr_b32 s37, s2, 7
    s_bfe_u32 s49, s2, 0x40003
    s_lshl1_add_u32 s4, s36, s37
    s_and_b32 s5, s49, 7
    s_add_u32 s41, s49, s36
    s_mul_i32 s38, s37, 3
    s_add_u32 s41, s41, s38
    s_mul_i32 s38, s41, 37
    s_lshr_b32 s38, s38, 8
    s_mul_i32 s38, s38, 7
    s_sub_u32 s41, s41, s38
    s_lshl3_add_u32 s38, s4, s3
    s_mul_i32 s42, s38, 14336
    s_lshl_b32 s46, s3, 11
    v_xor_b32 v27, 64, v26
    v_add_u32 v27, 6144, v27
    v_and_b32 v9, 2, v6
    v_xor_b32 v9, v9, v7
    v_mul_u32_u24 v8, 2688, v6
    v_min_u32 v28, 6, v9
    v_lshl_add_u32 v28, v28, 4, v8
    v_xor_b32 v9, 4, v9
    v_min_u32 v29, 6, v9
    v_lshl_add_u32 v29, v29, 4, v8
    v_add_u32 v29, 20480, v29
    s_mul_i32 s43, s5, 112
    s_mov_b32 s10, 0x001c0000
    s_mov_b32 s11, 0x00020000
    s_mov_b32 s14, 0x00126000
    s_mov_b32 s15, 0x00020000
    s_mov_b32 s34, 0x01000000
    s_mov_b32 s35, 0x00020000
    s_cmp_ge_u32 s49, 8
    s_cbranch_scc1 .Lq
    s_lshr_b32 s36, s3, 2
    s_and_b32 s37, s3, 1
    s_lshl1_add_u32 s36, s36, s37
    s_mul_i32 s36, s36, 43008
    s_and_b32 s37, s3, 2
    s_mul_i32 s37, s37, 448
    s_add_u32 s43, s43, s36
    s_add_u32 s43, s43, s37
    s_add_u32 s43, s43, 896
    s_add_u32 s47, s46, 16384
    s_waitcnt lgkmcnt(0)
    s_lshl_b32 s44, s41, 7
    s_add_u32 m0, s46, 0
    s_add_u32 s44, s44, s42
    buffer_load_dwordx4 v26, s[8:11], s44 offen lds
    buffer_load_dwordx4 v27, s[8:11], s44 offen offset:1024 lds
    s_mul_i32 s45, s41, 172032
    s_add_u32 m0, s47, 0
    s_add_u32 s45, s45, s43
    buffer_load_dwordx4 v28, s[12:15], s45 offen lds
    s_add_u32 s41, s41, 1
    s_cmp_eq_u32 s41, 7
    s_cselect_b32 s41, 0, s41
    buffer_load_dwordx4 v29, s[12:15], s45 offen offset:1024 lds
    buffer_load_dword v5, off, s[32:35], 0 sc1
    s_lshl_b32 s44, s41, 7
    s_add_u32 m0, s46, 32768
    s_add_u32 s44, s44, s42
    buffer_load_dwordx4 v26, s[8:11], s44 offen lds
    buffer_load_dwordx4 v27, s[8:11], s44 offen offset:1024 lds
    s_mul_i32 s45, s41, 172032
    s_add_u32 m0, s47, 32768
    s_add_u32 s45, s45, s43
    buffer_load_dwordx4 v28, s[12:15], s45 offen lds
    s_add_u32 s41, s41, 1
    s_cmp_eq_u32 s41, 7
    s_cselect_b32 s41, 0, s41
    buffer_load_dwordx4 v29, s[12:15], s45 offen offset:1024 lds
    s_lshl_b32 s44, s41, 7
    s_add_u32 m0, s46, 65536
    s_add_u32 s44, s44, s42
    buffer_load_dwordx4 v26, s[8:11], s44 offen lds
    buffer_load_dwordx4 v27, s[8:11], s44 offen offset:1024 lds
    s_mul_i32 s45, s41, 172032
    s_add_u32 m0, s47, 65536
    s_add_u32 s45, s45, s43
    buffer_load_dwordx4 v28, s[12:15], s45 offen lds
    s_add_u32 s41, s41, 1
    s_cmp_eq_u32 s41, 7
    s_cselect_b32 s41, 0, s41
    buffer_load_dwordx4 v29, s[12:15], s45 offen offset:1024 lds
    s_load_dwordx2 s[16:17], s[0:1], 16
    s_load_dwordx4 s[36:39], s[0:1], 32
    s_load_dwordx2 s[24:25], s[0:1], 48
    s_load_dwordx2 s[28:29], s[0:1], 56
    v_and_b32 v2, 15, v1
    v_lshlrev_b32 v4, 4, v1
    s_mov_b32 s18, 0x00062000
    s_mov_b32 s19, 0x00020000
    s_mov_b32 s22, 0x00188000
    s_mov_b32 s23, 0x00020000
    s_mov_b32 s26, 0x00188000
    s_mov_b32 s27, 0x00020000
    s_mov_b32 s30, 0x001c0000
    s_mov_b32 s31, 0x00020000
    s_sub_u32 s6, 13, s49
    s_cmp_ge_u32 s2, 128
    s_cselect_b32 s6, s6, s49
    s_cmp_ge_u32 s49, 14
    s_cselect_b32 s6, s5, s6
    s_cmp_ge_u32 s6, 7
    s_cselect_b32 s40, 1, 0
    s_mul_i32 s7, s40, 7
    s_sub_u32 s7, s6, s7
    s_and_b32 s57, s2, 7
    s_cmp_eq_u32 s57, 7
    s_cselect_b32 s57, 0, s57
    s_mov_b32 s50, s57
    s_lshl_b32 s53, s3, 12
    s_mov_b32 s48, 0x20000
    s_lshr_b32 s62, s3, 2
    s_mul_i32 s51, s62, 114688
    s_and_b32 s63, s3, 1
    s_lshl1_add_u32 s63, s6, s63
    s_lshl_b32 s63, s63, 7
    s_add_u32 s51, s51, s63
    s_and_b32 s63, s3, 3
    s_lshl_b32 s52, s62, 1
    s_xor_b32 s63, s63, s52
    v_lshrrev_b32 v6, 3, v1
    v_and_b32 v7, 6, v6
    v_xor_b32 v7, v7, v1
    v_and_b32 v7, 7, v7
    v_lshlrev_b32 v7, 4, v7
    v_mul_u32_u24 v8, 3584, v6
    v_add_u32 v10, v7, v8
    v_mul_u32_u24 v8, 896, v6
    v_add_u32 v11, v7, v8
    v_lshrrev_b32 v7, 1, v2
    v_xor_b32 v7, v7, v3
    v_lshlrev_b32 v7, 4, v7
    v_lshl_add_u32 v7, v2, 7, v7
    s_and_b32 s52, s53, 0x3000
    v_add_u32 v30, s52, v7
    v_xor_b32 v31, 64, v30
    v_and_b32 v6, 3, v6
    v_lshrrev_b32 v7, 2, v2
    v_lshl_add_u32 v7, v3, 3, v7
    v_lshlrev_b32 v7, 7, v7
    s_mul_i32 s52, s62, 7
    v_and_b32 v8, 3, v1
    v_add_u32 v8, s52, v8
    v_and_b32 v9, 3, v8
    v_lshl_add_u32 v7, v9, 3, v7
    v_add_u32 v7, 16384, v7
    v_lshrrev_b32 v8, 2, v8
    v_xor_b32 v9, v8, v6
    v_lshl_add_u32 v32, v9, 5, v7
    v_add_u32 v8, 1, v8
    v_xor_b32 v9, v8, v6
    v_lshl_add_u32 v33, v9, 5, v7
    s_and_b32 s52, s3, 3
    v_xor_b32 v6, s52, v6
    v_lshrrev_b32 v7, 2, v1
    v_lshlrev_b32 v7, 7, v7
    v_lshl_add_u32 v7, v6, 5, v7
    v_and_b32 v8, 3, v1
    v_lshl_add_u32 v7, v8, 3, v7
    v_and_b32 v8, 32, v1
    v_lshl_add_u32 v7, v8, 5, v7
    s_lshl_b32 s52, s62, 12
    v_add_u32 v12, s52, v7
    v_add_u32 v13, 65536, v12
    s_and_b32 s52, s3, 3
    v_and_b32 v8, 3, v1
    v_lshlrev_b32 v8, 3, v8
    v_add_u32 v8, 98304, v8
    v_lshrrev_b32 v6, 2, v1
    v_lshrrev_b32 v7, 2, v2
    v_min_u32 v7, 2, v7
    v_mad_u32_u24 v7, v3, 3, v7
    v_add_u32 v7, 16, v7
    v_bfe_u32 v9, v6, 1, 2
    v_xor_b32 v9, s52, v9
    v_lshl_add_u32 v9, v9, 5, v8
    v_lshl_add_u32 v132, v6, 7, v9
    v_xor_b32 v133, 64, v132
    v_bfe_u32 v9, v7, 1, 2
    v_xor_b32 v9, s52, v9
    v_lshl_add_u32 v9, v9, 5, v8
    v_lshl_add_u32 v134, v7, 7, v9
    v_xor_b32 v135, 64, v134
    v_mov_b32 v14, 0x3f803f80
    v_mov_b32 v15, 0x3f803f80
    v_mov_b32 v16, 0x3f803f80
    v_mov_b32 v17, 0x3f803f80
    s_mov_b32 s55, 0x3b124925
    s_mov_b32 s56, 0x3fb8aa3b
    s_mov_b32 s58, 0x358637bd
    s_mov_b32 s59, 0x358637bd
    s_bitcmp1_b32 s3, 1
    s_waitcnt lgkmcnt(0)
    s_cselect_b32 s20, s38, s36
    s_cselect_b32 s21, s39, s37
    v_mov_b32 v116, 0
    v_mov_b32 v117, 0
    v_mov_b32 v118, 0
    v_mov_b32 v119, 0
    v_mov_b32 v120, 0
    v_mov_b32 v121, 0
    v_mov_b32 v122, 0
    v_mov_b32 v123, 0
    v_mov_b32 v124, 0
    v_mov_b32 v125, 0
    v_mov_b32 v126, 0
    v_mov_b32 v127, 0
    v_mov_b32 v128, 0
    v_mov_b32 v129, 0
    v_mov_b32 v130, 0
    v_mov_b32 v131, 0
    v_mov_b32 v208, 0
    v_mov_b32 v209, 0
    v_mov_b32 v210, 0
    v_mov_b32 v211, 0
    v_mov_b32 v212, 0
    v_mov_b32 v213, 0
    v_mov_b32 v214, 0
    v_mov_b32 v215, 0
    v_mov_b32 v216, 0
    v_mov_b32 v217, 0
    v_mov_b32 v218, 0
    v_mov_b32 v219, 0
    v_mov_b32 v220, 0
    v_mov_b32 v221, 0
    v_mov_b32 v222, 0
    v_mov_b32 v223, 0
    s_waitcnt vmcnt(9)
    s_barrier
    ds_read_b128 v[36:39], v30 offset:0
    ds_read_b128 v[40:43], v30 offset:2048
    ds_read_b64_tr_b16 v[52:53], v32 offset:0
    ds_read_b64_tr_b16 v[54:55], v32 offset:512
    ds_read_b64_tr_b16 v[56:57], v33 offset:0
    ds_read_b64_tr_b16 v[58:59], v33 offset:512
    ds_read_b64_tr_b16 v[60:61], v32 offset:4096
    ds_read_b64_tr_b16 v[62:63], v32 offset:4608
    ds_read_b64_tr_b16 v[64:65], v33 offset:4096
    ds_read_b64_tr_b16 v[66:67], v33 offset:4608
    s_waitcnt lgkmcnt(0)
    v_mfma_f32_16x16x32_bf16 v[84:87], v[36:39], v[52:55], 0
    ds_read_b128 v[44:47], v31 offset:0
    ds_read_b128 v[48:51], v31 offset:2048
    v_mfma_f32_16x16x32_bf16 v[100:103], v[40:43], v[52:55], 0
    ds_read_b64_tr_b16 v[68:69], v32 offset:8192
    ds_read_b64_tr_b16 v[70:71], v32 offset:8704
    s_lshl_b32 s44, s41, 7
    s_add_u32 m0, s46, 98304
    s_add_u32 s44, s44, s42
    buffer_load_dwordx4 v26, s[8:11], s44 offen lds
    v_mfma_f32_16x16x32_bf16 v[88:91], v[36:39], v[56:59], 0
    ds_read_b64_tr_b16 v[72:73], v33 offset:8192
    v_mfma_f32_16x16x32_bf16 v[104:107], v[40:43], v[56:59], 0
    ds_read_b64_tr_b16 v[74:75], v33 offset:8704
    buffer_load_dwordx4 v27, s[8:11], s44 offen offset:1024 lds
    v_mfma_f32_16x16x32_bf16 v[92:95], v[36:39], v[60:63], 0
    ds_read_b64_tr_b16 v[76:77], v32 offset:12288
    v_mfma_f32_16x16x32_bf16 v[108:111], v[40:43], v[60:63], 0
    ds_read_b64_tr_b16 v[78:79], v32 offset:12800
    s_mul_i32 s45, s41, 172032
    s_add_u32 m0, s47, 98304
    s_add_u32 s45, s45, s43
    buffer_load_dwordx4 v28, s[12:15], s45 offen lds
    s_add_u32 s41, s41, 1
    s_cmp_eq_u32 s41, 7
    s_cselect_b32 s41, 0, s41
    v_mfma_f32_16x16x32_bf16 v[96:99], v[36:39], v[64:67], 0
    ds_read_b64_tr_b16 v[80:81], v33 offset:12288
    v_mfma_f32_16x16x32_bf16 v[112:115], v[40:43], v[64:67], 0
    ds_read_b64_tr_b16 v[82:83], v33 offset:12800
    buffer_load_dwordx4 v29, s[12:15], s45 offen offset:1024 lds
    s_cmp_eq_u32 s62, 0
    s_cbranch_scc0 .Ls_1
    v_mfma_f32_16x16x32_bf16 v[116:119], v[36:39], v[14:17], v[116:119]
    v_mfma_f32_16x16x32_bf16 v[124:127], v[36:39], v[36:39], v[124:127]
    v_mfma_f32_16x16x32_bf16 v[120:123], v[40:43], v[14:17], v[120:123]
    v_mfma_f32_16x16x32_bf16 v[128:131], v[40:43], v[40:43], v[128:131]
.Ls_1:
    s_cmp_eq_u32 s63, 0
    s_cbranch_scc0 .Ls_2
    v_mfma_f32_16x16x32_bf16 v[208:211], v[14:17], v[52:55], v[208:211]
    v_mfma_f32_16x16x32_bf16 v[212:215], v[14:17], v[56:59], v[212:215]
    v_mfma_f32_16x16x32_bf16 v[216:219], v[14:17], v[60:63], v[216:219]
    v_mfma_f32_16x16x32_bf16 v[220:223], v[14:17], v[64:67], v[220:223]
.Ls_2:
    s_waitcnt vmcnt(8) lgkmcnt(0)
    s_barrier
    v_add_u32 v5, 32, v5
    v_mfma_f32_16x16x32_bf16 v[84:87], v[44:47], v[68:71], v[84:87]
    ds_read_b128 v[36:39], v30 offset:32768
    ds_read_b128 v[40:43], v30 offset:34816
    v_mfma_f32_16x16x32_bf16 v[100:103], v[48:51], v[68:71], v[100:103]
    ds_read_b64_tr_b16 v[52:53], v32 offset:32768
    ds_read_b64_tr_b16 v[54:55], v32 offset:33280
    s_lshl_b32 s44, s41, 7
    s_add_u32 m0, s46, 131072
    s_add_u32 s44, s44, s42
    buffer_load_dwordx4 v26, s[8:11], s44 offen lds
    v_mfma_f32_16x16x32_bf16 v[88:91], v[44:47], v[72:75], v[88:91]
    ds_read_b64_tr_b16 v[56:57], v33 offset:32768
    v_mfma_f32_16x16x32_bf16 v[104:107], v[48:51], v[72:75], v[104:107]
    ds_read_b64_tr_b16 v[58:59], v33 offset:33280
    buffer_load_dwordx4 v27, s[8:11], s44 offen offset:1024 lds
    v_mfma_f32_16x16x32_bf16 v[92:95], v[44:47], v[76:79], v[92:95]
    ds_read_b64_tr_b16 v[60:61], v32 offset:36864
    v_mfma_f32_16x16x32_bf16 v[108:111], v[48:51], v[76:79], v[108:111]
    ds_read_b64_tr_b16 v[62:63], v32 offset:37376
    s_mul_i32 s45, s41, 172032
    s_add_u32 m0, s47, 131072
    s_add_u32 s45, s45, s43
    buffer_load_dwordx4 v28, s[12:15], s45 offen lds
    s_add_u32 s41, s41, 1
    s_cmp_eq_u32 s41, 7
    s_cselect_b32 s41, 0, s41
    v_mfma_f32_16x16x32_bf16 v[96:99], v[44:47], v[80:83], v[96:99]
    ds_read_b64_tr_b16 v[64:65], v33 offset:36864
    v_mfma_f32_16x16x32_bf16 v[112:115], v[48:51], v[80:83], v[112:115]
    ds_read_b64_tr_b16 v[66:67], v33 offset:37376
    buffer_load_dwordx4 v29, s[12:15], s45 offen offset:1024 lds
    s_cmp_eq_u32 s62, 1
    s_cbranch_scc0 .Ls_3
    v_mfma_f32_16x16x32_bf16 v[116:119], v[44:47], v[14:17], v[116:119]
    v_mfma_f32_16x16x32_bf16 v[124:127], v[44:47], v[44:47], v[124:127]
    v_mfma_f32_16x16x32_bf16 v[120:123], v[48:51], v[14:17], v[120:123]
    v_mfma_f32_16x16x32_bf16 v[128:131], v[48:51], v[48:51], v[128:131]
.Ls_3:
    s_cmp_eq_u32 s63, 1
    s_cbranch_scc0 .Ls_4
    v_mfma_f32_16x16x32_bf16 v[208:211], v[14:17], v[68:71], v[208:211]
    v_mfma_f32_16x16x32_bf16 v[212:215], v[14:17], v[72:75], v[212:215]
    v_mfma_f32_16x16x32_bf16 v[216:219], v[14:17], v[76:79], v[216:219]
    v_mfma_f32_16x16x32_bf16 v[220:223], v[14:17], v[80:83], v[220:223]
.Ls_4:
    s_waitcnt lgkmcnt(0)
    v_mfma_f32_16x16x32_bf16 v[84:87], v[36:39], v[52:55], v[84:87]
    ds_read_b128 v[44:47], v31 offset:32768
    ds_read_b128 v[48:51], v31 offset:34816
    v_mfma_f32_16x16x32_bf16 v[100:103], v[40:43], v[52:55], v[100:103]
    ds_read_b64_tr_b16 v[68:69], v32 offset:40960
    ds_read_b64_tr_b16 v[70:71], v32 offset:41472
    v_mfma_f32_16x16x32_bf16 v[88:91], v[36:39], v[56:59], v[88:91]
    ds_read_b64_tr_b16 v[72:73], v33 offset:40960
    v_mfma_f32_16x16x32_bf16 v[104:107], v[40:43], v[56:59], v[104:107]
    ds_read_b64_tr_b16 v[74:75], v33 offset:41472
    v_mfma_f32_16x16x32_bf16 v[92:95], v[36:39], v[60:63], v[92:95]
    ds_read_b64_tr_b16 v[76:77], v32 offset:45056
    v_mfma_f32_16x16x32_bf16 v[108:111], v[40:43], v[60:63], v[108:111]
    ds_read_b64_tr_b16 v[78:79], v32 offset:45568
    v_mfma_f32_16x16x32_bf16 v[96:99], v[36:39], v[64:67], v[96:99]
    ds_read_b64_tr_b16 v[80:81], v33 offset:45056
    v_mfma_f32_16x16x32_bf16 v[112:115], v[40:43], v[64:67], v[112:115]
    ds_read_b64_tr_b16 v[82:83], v33 offset:45568
    s_cmp_eq_u32 s62, 0
    s_cbranch_scc0 .Ls_5
    v_mfma_f32_16x16x32_bf16 v[116:119], v[36:39], v[14:17], v[116:119]
    v_mfma_f32_16x16x32_bf16 v[124:127], v[36:39], v[36:39], v[124:127]
    v_mfma_f32_16x16x32_bf16 v[120:123], v[40:43], v[14:17], v[120:123]
    v_mfma_f32_16x16x32_bf16 v[128:131], v[40:43], v[40:43], v[128:131]
.Ls_5:
    s_cmp_eq_u32 s63, 2
    s_cbranch_scc0 .Ls_6
    v_mfma_f32_16x16x32_bf16 v[208:211], v[14:17], v[52:55], v[208:211]
    v_mfma_f32_16x16x32_bf16 v[212:215], v[14:17], v[56:59], v[212:215]
    v_mfma_f32_16x16x32_bf16 v[216:219], v[14:17], v[60:63], v[216:219]
    v_mfma_f32_16x16x32_bf16 v[220:223], v[14:17], v[64:67], v[220:223]
.Ls_6:
    s_waitcnt vmcnt(8) lgkmcnt(0)
    s_barrier
    v_add_u32 v30, 0x00010000, v30
    v_add_u32 v31, 0x00010000, v31
    v_add_u32 v32, 0x00010000, v32
    v_add_u32 v33, 0x00010000, v33
    v_mfma_f32_16x16x32_bf16 v[84:87], v[44:47], v[68:71], v[84:87]
    ds_read_b128 v[36:39], v30 offset:0
    ds_read_b128 v[40:43], v30 offset:2048
    v_mfma_f32_16x16x32_bf16 v[100:103], v[48:51], v[68:71], v[100:103]
    ds_read_b64_tr_b16 v[52:53], v32 offset:0
    ds_read_b64_tr_b16 v[54:55], v32 offset:512
    s_lshl_b32 s44, s41, 7
    s_add_u32 m0, s46, 0
    s_add_u32 s44, s44, s42
    buffer_load_dwordx4 v26, s[8:11], s44 offen lds
    v_mfma_f32_16x16x32_bf16 v[88:91], v[44:47], v[72:75], v[88:91]
    ds_read_b64_tr_b16 v[56:57], v33 offset:0
    v_mfma_f32_16x16x32_bf16 v[104:107], v[48:51], v[72:75], v[104:107]
    ds_read_b64_tr_b16 v[58:59], v33 offset:512
    buffer_load_dwordx4 v27, s[8:11], s44 offen offset:1024 lds
    v_mfma_f32_16x16x32_bf16 v[92:95], v[44:47], v[76:79], v[92:95]
    ds_read_b64_tr_b16 v[60:61], v32 offset:4096
    v_mfma_f32_16x16x32_bf16 v[108:111], v[48:51], v[76:79], v[108:111]
    ds_read_b64_tr_b16 v[62:63], v32 offset:4608
    s_mul_i32 s45, s41, 172032
    s_add_u32 m0, s47, 0
    s_add_u32 s45, s45, s43
    buffer_load_dwordx4 v28, s[12:15], s45 offen lds
    s_add_u32 s41, s41, 1
    s_cmp_eq_u32 s41, 7
    s_cselect_b32 s41, 0, s41
    v_mfma_f32_16x16x32_bf16 v[96:99], v[44:47], v[80:83], v[96:99]
    ds_read_b64_tr_b16 v[64:65], v33 offset:4096
    v_mfma_f32_16x16x32_bf16 v[112:115], v[48:51], v[80:83], v[112:115]
    ds_read_b64_tr_b16 v[66:67], v33 offset:4608
    buffer_load_dwordx4 v29, s[12:15], s45 offen offset:1024 lds
    s_cmp_eq_u32 s62, 1
    s_cbranch_scc0 .Ls_7
    v_mfma_f32_16x16x32_bf16 v[116:119], v[44:47], v[14:17], v[116:119]
    v_mfma_f32_16x16x32_bf16 v[124:127], v[44:47], v[44:47], v[124:127]
    v_mfma_f32_16x16x32_bf16 v[120:123], v[48:51], v[14:17], v[120:123]
    v_mfma_f32_16x16x32_bf16 v[128:131], v[48:51], v[48:51], v[128:131]
.Ls_7:
    s_cmp_eq_u32 s63, 3
    s_cbranch_scc0 .Ls_8
    v_mfma_f32_16x16x32_bf16 v[208:211], v[14:17], v[68:71], v[208:211]
    v_mfma_f32_16x16x32_bf16 v[212:215], v[14:17], v[72:75], v[212:215]
    v_mfma_f32_16x16x32_bf16 v[216:219], v[14:17], v[76:79], v[216:219]
    v_mfma_f32_16x16x32_bf16 v[220:223], v[14:17], v[80:83], v[220:223]
.Ls_8:
    s_waitcnt lgkmcnt(0)
    v_mfma_f32_16x16x32_bf16 v[84:87], v[36:39], v[52:55], v[84:87]
    ds_read_b128 v[44:47], v31 offset:0
    ds_read_b128 v[48:51], v31 offset:2048
    v_mfma_f32_16x16x32_bf16 v[100:103], v[40:43], v[52:55], v[100:103]
    ds_read_b64_tr_b16 v[68:69], v32 offset:8192
    ds_read_b64_tr_b16 v[70:71], v32 offset:8704
    s_lshl_b32 s44, s41, 7
    s_add_u32 m0, s46, 32768
    s_add_u32 s44, s44, s42
    buffer_load_dwordx4 v26, s[8:11], s44 offen lds
    v_mfma_f32_16x16x32_bf16 v[88:91], v[36:39], v[56:59], v[88:91]
    ds_read_b64_tr_b16 v[72:73], v33 offset:8192
    v_mfma_f32_16x16x32_bf16 v[104:107], v[40:43], v[56:59], v[104:107]
    ds_read_b64_tr_b16 v[74:75], v33 offset:8704
    buffer_load_dwordx4 v27, s[8:11], s44 offen offset:1024 lds
    v_mfma_f32_16x16x32_bf16 v[92:95], v[36:39], v[60:63], v[92:95]
    ds_read_b64_tr_b16 v[76:77], v32 offset:12288
    v_mfma_f32_16x16x32_bf16 v[108:111], v[40:43], v[60:63], v[108:111]
    ds_read_b64_tr_b16 v[78:79], v32 offset:12800
    s_mul_i32 s45, s41, 172032
    s_add_u32 m0, s47, 32768
    s_add_u32 s45, s45, s43
    buffer_load_dwordx4 v28, s[12:15], s45 offen lds
    v_mfma_f32_16x16x32_bf16 v[96:99], v[36:39], v[64:67], v[96:99]
    ds_read_b64_tr_b16 v[80:81], v33 offset:12288
    v_mfma_f32_16x16x32_bf16 v[112:115], v[40:43], v[64:67], v[112:115]
    ds_read_b64_tr_b16 v[82:83], v33 offset:12800
    buffer_load_dwordx4 v29, s[12:15], s45 offen offset:1024 lds
    s_cmp_eq_u32 s62, 0
    s_cbranch_scc0 .Ls_9
    v_mfma_f32_16x16x32_bf16 v[116:119], v[36:39], v[14:17], v[116:119]
    v_mfma_f32_16x16x32_bf16 v[124:127], v[36:39], v[36:39], v[124:127]
    v_mfma_f32_16x16x32_bf16 v[120:123], v[40:43], v[14:17], v[120:123]
    v_mfma_f32_16x16x32_bf16 v[128:131], v[40:43], v[40:43], v[128:131]
.Ls_9:
    s_cmp_eq_u32 s63, 0
    s_cbranch_scc0 .Ls_10
    v_mfma_f32_16x16x32_bf16 v[208:211], v[14:17], v[52:55], v[208:211]
    v_mfma_f32_16x16x32_bf16 v[212:215], v[14:17], v[56:59], v[212:215]
    v_mfma_f32_16x16x32_bf16 v[216:219], v[14:17], v[60:63], v[216:219]
    v_mfma_f32_16x16x32_bf16 v[220:223], v[14:17], v[64:67], v[220:223]
.Ls_10:
    s_waitcnt vmcnt(12) lgkmcnt(0)
    s_barrier
    v_mfma_f32_16x16x32_bf16 v[84:87], v[44:47], v[68:71], v[84:87]
    ds_read_b128 v[36:39], v30 offset:32768
    ds_read_b128 v[40:43], v30 offset:34816
    v_mfma_f32_16x16x32_bf16 v[100:103], v[48:51], v[68:71], v[100:103]
    ds_read_b64_tr_b16 v[52:53], v32 offset:32768
    ds_read_b64_tr_b16 v[54:55], v32 offset:33280
    s_mul_i32 s52, s50, 229376
    s_add_u32 s52, s52, s51
    s_add_u32 s50, s50, 1
    s_cmp_eq_u32 s50, 7
    s_cselect_b32 s50, 0, s50
    s_add_u32 m0, s53, 65536
    s_nop 0
    buffer_load_dwordx4 v10, s[20:23], s52 offen offset:0 lds
    v_mfma_f32_16x16x32_bf16 v[88:91], v[44:47], v[72:75], v[88:91]
    ds_read_b64_tr_b16 v[56:57], v33 offset:32768
    v_mfma_f32_16x16x32_bf16 v[104:107], v[48:51], v[72:75], v[104:107]
    ds_read_b64_tr_b16 v[58:59], v33 offset:33280
    s_add_u32 s52, s52, 27648
    buffer_load_dwordx4 v10, s[20:23], s52 offen offset:1024 lds
    v_mfma_f32_16x16x32_bf16 v[92:95], v[44:47], v[76:79], v[92:95]
    ds_read_b64_tr_b16 v[60:61], v32 offset:36864
    v_mfma_f32_16x16x32_bf16 v[108:111], v[48:51], v[76:79], v[108:111]
    ds_read_b64_tr_b16 v[62:63], v32 offset:37376
    s_add_u32 s52, s52, 27648
    buffer_load_dwordx4 v10, s[20:23], s52 offen offset:2048 lds
    v_mfma_f32_16x16x32_bf16 v[96:99], v[44:47], v[80:83], v[96:99]
    ds_read_b64_tr_b16 v[64:65], v33 offset:36864
    v_mfma_f32_16x16x32_bf16 v[112:115], v[48:51], v[80:83], v[112:115]
    ds_read_b64_tr_b16 v[66:67], v33 offset:37376
    s_add_u32 s52, s52, 27648
    buffer_load_dwordx4 v10, s[20:23], s52 offen offset:3072 lds
    s_cmp_eq_u32 s62, 1
    s_cbranch_scc0 .Ls_11
    v_mfma_f32_16x16x32_bf16 v[116:119], v[44:47], v[14:17], v[116:119]
    v_mfma_f32_16x16x32_bf16 v[124:127], v[44:47], v[44:47], v[124:127]
    v_mfma_f32_16x16x32_bf16 v[120:123], v[48:51], v[14:17], v[120:123]
    v_mfma_f32_16x16x32_bf16 v[128:131], v[48:51], v[48:51], v[128:131]
.Ls_11:
    s_cmp_eq_u32 s63, 1
    s_cbranch_scc0 .Ls_12
    v_mfma_f32_16x16x32_bf16 v[208:211], v[14:17], v[68:71], v[208:211]
    v_mfma_f32_16x16x32_bf16 v[212:215], v[14:17], v[72:75], v[212:215]
    v_mfma_f32_16x16x32_bf16 v[216:219], v[14:17], v[76:79], v[216:219]
    v_mfma_f32_16x16x32_bf16 v[220:223], v[14:17], v[80:83], v[220:223]
.Ls_12:
    s_waitcnt lgkmcnt(0)
    v_mfma_f32_16x16x32_bf16 v[84:87], v[36:39], v[52:55], v[84:87]
    ds_read_b128 v[44:47], v31 offset:32768
    ds_read_b128 v[48:51], v31 offset:34816
    v_mfma_f32_16x16x32_bf16 v[100:103], v[40:43], v[52:55], v[100:103]
    ds_read_b64_tr_b16 v[68:69], v32 offset:40960
    ds_read_b64_tr_b16 v[70:71], v32 offset:41472
    v_mfma_f32_16x16x32_bf16 v[88:91], v[36:39], v[56:59], v[88:91]
    ds_read_b64_tr_b16 v[72:73], v33 offset:40960
    v_mfma_f32_16x16x32_bf16 v[104:107], v[40:43], v[56:59], v[104:107]
    ds_read_b64_tr_b16 v[74:75], v33 offset:41472
    v_mfma_f32_16x16x32_bf16 v[92:95], v[36:39], v[60:63], v[92:95]
    ds_read_b64_tr_b16 v[76:77], v32 offset:45056
    v_mfma_f32_16x16x32_bf16 v[108:111], v[40:43], v[60:63], v[108:111]
    ds_read_b64_tr_b16 v[78:79], v32 offset:45568
    v_mfma_f32_16x16x32_bf16 v[96:99], v[36:39], v[64:67], v[96:99]
    ds_read_b64_tr_b16 v[80:81], v33 offset:45056
    v_mfma_f32_16x16x32_bf16 v[112:115], v[40:43], v[64:67], v[112:115]
    ds_read_b64_tr_b16 v[82:83], v33 offset:45568
    s_cmp_eq_u32 s62, 0
    s_cbranch_scc0 .Ls_13
    v_mfma_f32_16x16x32_bf16 v[116:119], v[36:39], v[14:17], v[116:119]
    v_mfma_f32_16x16x32_bf16 v[124:127], v[36:39], v[36:39], v[124:127]
    v_mfma_f32_16x16x32_bf16 v[120:123], v[40:43], v[14:17], v[120:123]
    v_mfma_f32_16x16x32_bf16 v[128:131], v[40:43], v[40:43], v[128:131]
.Ls_13:
    s_cmp_eq_u32 s63, 2
    s_cbranch_scc0 .Ls_14
    v_mfma_f32_16x16x32_bf16 v[208:211], v[14:17], v[52:55], v[208:211]
    v_mfma_f32_16x16x32_bf16 v[212:215], v[14:17], v[56:59], v[212:215]
    v_mfma_f32_16x16x32_bf16 v[216:219], v[14:17], v[60:63], v[216:219]
    v_mfma_f32_16x16x32_bf16 v[220:223], v[14:17], v[64:67], v[220:223]
.Ls_14:
    s_waitcnt vmcnt(12) lgkmcnt(0)
    s_barrier
    v_add_u32 v30, 0x00010000, v30
    v_add_u32 v31, 0x00010000, v31
    v_add_u32 v32, 0x00010000, v32
    v_add_u32 v33, 0x00010000, v33
    v_mfma_f32_16x16x32_bf16 v[84:87], v[44:47], v[68:71], v[84:87]
    ds_read_b128 v[36:39], v30 offset:0
    ds_read_b128 v[40:43], v30 offset:2048
    v_mfma_f32_16x16x32_bf16 v[100:103], v[48:51], v[68:71], v[100:103]
    ds_read_b64_tr_b16 v[52:53], v32 offset:0
    ds_read_b64_tr_b16 v[54:55], v32 offset:512
    s_lshl_b32 s44, s5, 7
    s_mov_b64 exec, 0x00000001
    buffer_load_dword v34, off, s[32:35], s44 offset:1028 sc1
    s_mov_b64 exec, -1
    s_mul_i32 s45, s3, 28672
    s_lshl_b32 s41, s7, 7
    s_add_u32 s45, s45, s41
    s_add_u32 m0, s53, 98304
    s_nop 0
    buffer_load_dwordx4 v11, s[16:19], s45 offen offset:0 lds
    v_mfma_f32_16x16x32_bf16 v[88:91], v[44:47], v[72:75], v[88:91]
    ds_read_b64_tr_b16 v[56:57], v33 offset:0
    v_mfma_f32_16x16x32_bf16 v[104:107], v[48:51], v[72:75], v[104:107]
    ds_read_b64_tr_b16 v[58:59], v33 offset:512
    s_add_u32 s45, s45, 6144
    buffer_load_dwordx4 v11, s[16:19], s45 offen offset:1024 lds
    v_mfma_f32_16x16x32_bf16 v[92:95], v[44:47], v[76:79], v[92:95]
    ds_read_b64_tr_b16 v[60:61], v32 offset:4096
    v_mfma_f32_16x16x32_bf16 v[108:111], v[48:51], v[76:79], v[108:111]
    ds_read_b64_tr_b16 v[62:63], v32 offset:4608
    s_add_u32 s45, s45, 6144
    buffer_load_dwordx4 v11, s[16:19], s45 offen offset:2048 lds
    v_mfma_f32_16x16x32_bf16 v[96:99], v[44:47], v[80:83], v[96:99]
    ds_read_b64_tr_b16 v[64:65], v33 offset:4096
    v_mfma_f32_16x16x32_bf16 v[112:115], v[48:51], v[80:83], v[112:115]
    ds_read_b64_tr_b16 v[66:67], v33 offset:4608
    s_add_u32 s45, s45, 6144
    buffer_load_dwordx4 v11, s[16:19], s45 offen offset:3072 lds
    s_cmp_eq_u32 s62, 1
    s_cbranch_scc0 .Ls_15
    v_mfma_f32_16x16x32_bf16 v[116:119], v[44:47], v[14:17], v[116:119]
    v_mfma_f32_16x16x32_bf16 v[124:127], v[44:47], v[44:47], v[124:127]
    v_mfma_f32_16x16x32_bf16 v[120:123], v[48:51], v[14:17], v[120:123]
    v_mfma_f32_16x16x32_bf16 v[128:131], v[48:51], v[48:51], v[128:131]
.Ls_15:
    s_cmp_eq_u32 s63, 3
    s_cbranch_scc0 .Ls_16
    v_mfma_f32_16x16x32_bf16 v[208:211], v[14:17], v[68:71], v[208:211]
    v_mfma_f32_16x16x32_bf16 v[212:215], v[14:17], v[72:75], v[212:215]
    v_mfma_f32_16x16x32_bf16 v[216:219], v[14:17], v[76:79], v[216:219]
    v_mfma_f32_16x16x32_bf16 v[220:223], v[14:17], v[80:83], v[220:223]
.Ls_16:
    s_waitcnt lgkmcnt(0)
    v_mfma_f32_16x16x32_bf16 v[84:87], v[36:39], v[52:55], v[84:87]
    ds_read_b128 v[44:47], v31 offset:0
    ds_read_b128 v[48:51], v31 offset:2048
    v_mfma_f32_16x16x32_bf16 v[100:103], v[40:43], v[52:55], v[100:103]
    ds_read_b64_tr_b16 v[68:69], v32 offset:8192
    ds_read_b64_tr_b16 v[70:71], v32 offset:8704
    v_mfma_f32_16x16x32_bf16 v[88:91], v[36:39], v[56:59], v[88:91]
    ds_read_b64_tr_b16 v[72:73], v33 offset:8192
    v_mfma_f32_16x16x32_bf16 v[104:107], v[40:43], v[56:59], v[104:107]
    ds_read_b64_tr_b16 v[74:75], v33 offset:8704
    v_mfma_f32_16x16x32_bf16 v[92:95], v[36:39], v[60:63], v[92:95]
    ds_read_b64_tr_b16 v[76:77], v32 offset:12288
    v_mfma_f32_16x16x32_bf16 v[108:111], v[40:43], v[60:63], v[108:111]
    ds_read_b64_tr_b16 v[78:79], v32 offset:12800
    v_mfma_f32_16x16x32_bf16 v[96:99], v[36:39], v[64:67], v[96:99]
    ds_read_b64_tr_b16 v[80:81], v33 offset:12288
    v_mfma_f32_16x16x32_bf16 v[112:115], v[40:43], v[64:67], v[112:115]
    ds_read_b64_tr_b16 v[82:83], v33 offset:12800
    s_cmp_eq_u32 s62, 0
    s_cbranch_scc0 .Ls_17
    v_mfma_f32_16x16x32_bf16 v[116:119], v[36:39], v[14:17], v[116:119]
    v_mfma_f32_16x16x32_bf16 v[124:127], v[36:39], v[36:39], v[124:127]
    v_mfma_f32_16x16x32_bf16 v[120:123], v[40:43], v[14:17], v[120:123]
    v_mfma_f32_16x16x32_bf16 v[128:131], v[40:43], v[40:43], v[128:131]
.Ls_17:
    s_cmp_eq_u32 s63, 0
    s_cbranch_scc0 .Ls_18
    v_mfma_f32_16x16x32_bf16 v[208:211], v[14:17], v[52:55], v[208:211]
    v_mfma_f32_16x16x32_bf16 v[212:215], v[14:17], v[56:59], v[212:215]
    v_mfma_f32_16x16x32_bf16 v[216:219], v[14:17], v[60:63], v[216:219]
    v_mfma_f32_16x16x32_bf16 v[220:223], v[14:17], v[64:67], v[220:223]
.Ls_18:
    s_waitcnt vmcnt(13) lgkmcnt(0)
    s_barrier
    v_add_u32 v30, 0xfffe0000, v30
    v_add_u32 v31, 0xfffe0000, v31
    v_add_u32 v32, 0xfffe0000, v32
    v_add_u32 v33, 0xfffe0000, v33
    v_mfma_f32_16x16x32_bf16 v[84:87], v[44:47], v[68:71], v[84:87]
    ds_read_b128 v[36:39], v30 offset:0
    ds_read_b128 v[40:43], v30 offset:2048
    v_mfma_f32_16x16x32_bf16 v[100:103], v[48:51], v[68:71], v[100:103]
    ds_read_b64_tr_b16 v[52:53], v32 offset:0
    ds_read_b64_tr_b16 v[54:55], v32 offset:512
    s_mul_i32 s45, s3, 21504
    s_lshl_b32 s41, s7, 7
    s_add_u32 s45, s45, s41
    s_mul_i32 s41, s3, 3072
    s_add_u32 m0, s41, 131072
    s_add_u32 s45, s45, 229376
    buffer_load_dwordx4 v11, s[16:19], s45 offen offset:0 lds
    v_mfma_f32_16x16x32_bf16 v[88:91], v[44:47], v[72:75], v[88:91]
    ds_read_b64_tr_b16 v[56:57], v33 offset:0
    v_mfma_f32_16x16x32_bf16 v[104:107], v[48:51], v[72:75], v[104:107]
    ds_read_b64_tr_b16 v[58:59], v33 offset:512
    s_add_u32 s45, s45, 6144
    buffer_load_dwordx4 v11, s[16:19], s45 offen offset:1024 lds
    v_mfma_f32_16x16x32_bf16 v[92:95], v[44:47], v[76:79], v[92:95]
    ds_read_b64_tr_b16 v[60:61], v32 offset:4096
    v_mfma_f32_16x16x32_bf16 v[108:111], v[48:51], v[76:79], v[108:111]
    ds_read_b64_tr_b16 v[62:63], v32 offset:4608
    s_add_u32 s45, s45, 6144
    buffer_load_dwordx4 v11, s[16:19], s45 offen offset:2048 lds
    v_mfma_f32_16x16x32_bf16 v[96:99], v[44:47], v[80:83], v[96:99]
    ds_read_b64_tr_b16 v[64:65], v33 offset:4096
    v_mfma_f32_16x16x32_bf16 v[112:115], v[48:51], v[80:83], v[112:115]
    ds_read_b64_tr_b16 v[66:67], v33 offset:4608
    s_cmp_eq_u32 s62, 1
    s_cbranch_scc0 .Ls_19
    v_mfma_f32_16x16x32_bf16 v[116:119], v[44:47], v[14:17], v[116:119]
    v_mfma_f32_16x16x32_bf16 v[124:127], v[44:47], v[44:47], v[124:127]
    v_mfma_f32_16x16x32_bf16 v[120:123], v[48:51], v[14:17], v[120:123]
    v_mfma_f32_16x16x32_bf16 v[128:131], v[48:51], v[48:51], v[128:131]
.Ls_19:
    s_cmp_eq_u32 s63, 1
    s_cbranch_scc0 .Ls_20
    v_mfma_f32_16x16x32_bf16 v[208:211], v[14:17], v[68:71], v[208:211]
    v_mfma_f32_16x16x32_bf16 v[212:215], v[14:17], v[72:75], v[212:215]
    v_mfma_f32_16x16x32_bf16 v[216:219], v[14:17], v[76:79], v[216:219]
    v_mfma_f32_16x16x32_bf16 v[220:223], v[14:17], v[80:83], v[220:223]
.Ls_20:
    s_waitcnt lgkmcnt(0)
    v_mfma_f32_16x16x32_bf16 v[84:87], v[36:39], v[52:55], v[84:87]
    ds_read_b128 v[44:47], v31 offset:0
    ds_read_b128 v[48:51], v31 offset:2048
    v_mfma_f32_16x16x32_bf16 v[100:103], v[40:43], v[52:55], v[100:103]
    ds_read_b64_tr_b16 v[68:69], v32 offset:8192
    ds_read_b64_tr_b16 v[70:71], v32 offset:8704
    v_mfma_f32_16x16x32_bf16 v[88:91], v[36:39], v[56:59], v[88:91]
    ds_read_b64_tr_b16 v[72:73], v33 offset:8192
    v_mfma_f32_16x16x32_bf16 v[104:107], v[40:43], v[56:59], v[104:107]
    ds_read_b64_tr_b16 v[74:75], v33 offset:8704
    v_mfma_f32_16x16x32_bf16 v[92:95], v[36:39], v[60:63], v[92:95]
    ds_read_b64_tr_b16 v[76:77], v32 offset:12288
    v_mfma_f32_16x16x32_bf16 v[108:111], v[40:43], v[60:63], v[108:111]
    ds_read_b64_tr_b16 v[78:79], v32 offset:12800
    v_mfma_f32_16x16x32_bf16 v[96:99], v[36:39], v[64:67], v[96:99]
    ds_read_b64_tr_b16 v[80:81], v33 offset:12288
    v_mfma_f32_16x16x32_bf16 v[112:115], v[40:43], v[64:67], v[112:115]
    ds_read_b64_tr_b16 v[82:83], v33 offset:12800
    s_cmp_eq_u32 s62, 0
    s_cbranch_scc0 .Ls_21
    v_mfma_f32_16x16x32_bf16 v[116:119], v[36:39], v[14:17], v[116:119]
    v_mfma_f32_16x16x32_bf16 v[124:127], v[36:39], v[36:39], v[124:127]
    v_mfma_f32_16x16x32_bf16 v[120:123], v[40:43], v[14:17], v[120:123]
    v_mfma_f32_16x16x32_bf16 v[128:131], v[40:43], v[40:43], v[128:131]
.Ls_21:
    s_cmp_eq_u32 s63, 2
    s_cbranch_scc0 .Ls_22
    v_mfma_f32_16x16x32_bf16 v[208:211], v[14:17], v[52:55], v[208:211]
    v_mfma_f32_16x16x32_bf16 v[212:215], v[14:17], v[56:59], v[212:215]
    v_mfma_f32_16x16x32_bf16 v[216:219], v[14:17], v[60:63], v[216:219]
    v_mfma_f32_16x16x32_bf16 v[220:223], v[14:17], v[64:67], v[220:223]
.Ls_22:
    s_waitcnt vmcnt(8) lgkmcnt(0)
    s_barrier
    v_mfma_f32_16x16x32_bf16 v[84:87], v[44:47], v[68:71], v[84:87]
    ds_read_b128 v[36:39], v30 offset:32768
    ds_read_b128 v[40:43], v30 offset:34816
    v_mfma_f32_16x16x32_bf16 v[100:103], v[48:51], v[68:71], v[100:103]
    ds_read_b64_tr_b16 v[52:53], v32 offset:32768
    ds_read_b64_tr_b16 v[54:55], v32 offset:33280
    s_mul_i32 s52, s50, 229376
    s_add_u32 s52, s52, s51
    s_add_u32 s50, s50, 1
    s_cmp_eq_u32 s50, 7
    s_cselect_b32 s50, 0, s50
    s_add_u32 m0, s53, 0
    s_nop 0
    buffer_load_dwordx4 v10, s[20:23], s52 offen offset:0 lds
    v_mfma_f32_16x16x32_bf16 v[88:91], v[44:47], v[72:75], v[88:91]
    ds_read_b64_tr_b16 v[56:57], v33 offset:32768
    v_mfma_f32_16x16x32_bf16 v[104:107], v[48:51], v[72:75], v[104:107]
    ds_read_b64_tr_b16 v[58:59], v33 offset:33280
    s_add_u32 s52, s52, 27648
    buffer_load_dwordx4 v10, s[20:23], s52 offen offset:1024 lds
    v_mfma_f32_16x16x32_bf16 v[92:95], v[44:47], v[76:79], v[92:95]
    ds_read_b64_tr_b16 v[60:61], v32 offset:36864
    v_mfma_f32_16x16x32_bf16 v[108:111], v[48:51], v[76:79], v[108:111]
    ds_read_b64_tr_b16 v[62:63], v32 offset:37376
    s_add_u32 s52, s52, 27648
    buffer_load_dwordx4 v10, s[20:23], s52 offen offset:2048 lds
    v_mfma_f32_16x16x32_bf16 v[96:99], v[44:47], v[80:83], v[96:99]
    ds_read_b64_tr_b16 v[64:65], v33 offset:36864
    v_mfma_f32_16x16x32_bf16 v[112:115], v[48:51], v[80:83], v[112:115]
    ds_read_b64_tr_b16 v[66:67], v33 offset:37376
    s_add_u32 s52, s52, 27648
    buffer_load_dwordx4 v10, s[20:23], s52 offen offset:3072 lds
    s_cmp_eq_u32 s62, 1
    s_cbranch_scc0 .Ls_23
    v_mfma_f32_16x16x32_bf16 v[116:119], v[44:47], v[14:17], v[116:119]
    v_mfma_f32_16x16x32_bf16 v[124:127], v[44:47], v[44:47], v[124:127]
    v_mfma_f32_16x16x32_bf16 v[120:123], v[48:51], v[14:17], v[120:123]
    v_mfma_f32_16x16x32_bf16 v[128:131], v[48:51], v[48:51], v[128:131]
.Ls_23:
    s_cmp_eq_u32 s63, 3
    s_cbranch_scc0 .Ls_24
    v_mfma_f32_16x16x32_bf16 v[208:211], v[14:17], v[68:71], v[208:211]
    v_mfma_f32_16x16x32_bf16 v[212:215], v[14:17], v[72:75], v[212:215]
    v_mfma_f32_16x16x32_bf16 v[216:219], v[14:17], v[76:79], v[216:219]
    v_mfma_f32_16x16x32_bf16 v[220:223], v[14:17], v[80:83], v[220:223]
.Ls_24:
    s_waitcnt lgkmcnt(0)
    v_mfma_f32_16x16x32_bf16 v[84:87], v[36:39], v[52:55], v[84:87]
    ds_read_b128 v[44:47], v31 offset:32768
    ds_read_b128 v[48:51], v31 offset:34816
    v_mfma_f32_16x16x32_bf16 v[100:103], v[40:43], v[52:55], v[100:103]
    ds_read_b64_tr_b16 v[68:69], v32 offset:40960
    ds_read_b64_tr_b16 v[70:71], v32 offset:41472
    v_mfma_f32_16x16x32_bf16 v[88:91], v[36:39], v[56:59], v[88:91]
    ds_read_b64_tr_b16 v[72:73], v33 offset:40960
    v_mfma_f32_16x16x32_bf16 v[104:107], v[40:43], v[56:59], v[104:107]
    ds_read_b64_tr_b16 v[74:75], v33 offset:41472
    v_mfma_f32_16x16x32_bf16 v[92:95], v[36:39], v[60:63], v[92:95]
    ds_read_b64_tr_b16 v[76:77], v32 offset:45056
    v_mfma_f32_16x16x32_bf16 v[108:111], v[40:43], v[60:63], v[108:111]
    ds_read_b64_tr_b16 v[78:79], v32 offset:45568
    v_mfma_f32_16x16x32_bf16 v[96:99], v[36:39], v[64:67], v[96:99]
    ds_read_b64_tr_b16 v[80:81], v33 offset:45056
    v_mfma_f32_16x16x32_bf16 v[112:115], v[40:43], v[64:67], v[112:115]
    ds_read_b64_tr_b16 v[82:83], v33 offset:45568
    s_cmp_eq_u32 s62, 0
    s_cbranch_scc0 .Ls_25
    v_mfma_f32_16x16x32_bf16 v[116:119], v[36:39], v[14:17], v[116:119]
    v_mfma_f32_16x16x32_bf16 v[124:127], v[36:39], v[36:39], v[124:127]
    v_mfma_f32_16x16x32_bf16 v[120:123], v[40:43], v[14:17], v[120:123]
    v_mfma_f32_16x16x32_bf16 v[128:131], v[40:43], v[40:43], v[128:131]
.Ls_25:
    s_cmp_eq_u32 s63, 0
    s_cbranch_scc0 .Ls_26
    v_mfma_f32_16x16x32_bf16 v[208:211], v[14:17], v[52:55], v[208:211]
    v_mfma_f32_16x16x32_bf16 v[212:215], v[14:17], v[56:59], v[212:215]
    v_mfma_f32_16x16x32_bf16 v[216:219], v[14:17], v[60:63], v[216:219]
    v_mfma_f32_16x16x32_bf16 v[220:223], v[14:17], v[64:67], v[220:223]
.Ls_26:
    s_waitcnt lgkmcnt(0)
    v_mfma_f32_16x16x32_bf16 v[84:87], v[44:47], v[68:71], v[84:87]
    ds_read_b64_tr_b16 v[144:145], v13 offset:0
    ds_read_b64_tr_b16 v[146:147], v13 offset:1024
    v_mfma_f32_16x16x32_bf16 v[100:103], v[48:51], v[68:71], v[100:103]
    ds_read_b64_tr_b16 v[148:149], v13 offset:8192
    ds_read_b64_tr_b16 v[150:151], v13 offset:9216
    v_mfma_f32_16x16x32_bf16 v[88:91], v[44:47], v[72:75], v[88:91]
    ds_read_b64_tr_b16 v[152:153], v13 offset:16384
    v_mfma_f32_16x16x32_bf16 v[104:107], v[48:51], v[72:75], v[104:107]
    ds_read_b64_tr_b16 v[154:155], v13 offset:17408
    v_mfma_f32_16x16x32_bf16 v[92:95], v[44:47], v[76:79], v[92:95]
    ds_read_b64_tr_b16 v[156:157], v13 offset:24576
    v_mfma_f32_16x16x32_bf16 v[108:111], v[48:51], v[76:79], v[108:111]
    ds_read_b64_tr_b16 v[158:159], v13 offset:25600
    v_mfma_f32_16x16x32_bf16 v[96:99], v[44:47], v[80:83], v[96:99]
    v_mfma_f32_16x16x32_bf16 v[112:115], v[48:51], v[80:83], v[112:115]
    s_cmp_eq_u32 s62, 1
    s_cbranch_scc0 .Ls_27
    v_mfma_f32_16x16x32_bf16 v[116:119], v[44:47], v[14:17], v[116:119]
    v_mfma_f32_16x16x32_bf16 v[124:127], v[44:47], v[44:47], v[124:127]
    v_mfma_f32_16x16x32_bf16 v[120:123], v[48:51], v[14:17], v[120:123]
    v_mfma_f32_16x16x32_bf16 v[128:131], v[48:51], v[48:51], v[128:131]
.Ls_27:
    s_cmp_eq_u32 s63, 1
    s_cbranch_scc0 .Ls_28
    v_mfma_f32_16x16x32_bf16 v[208:211], v[14:17], v[68:71], v[208:211]
    v_mfma_f32_16x16x32_bf16 v[212:215], v[14:17], v[72:75], v[212:215]
    v_mfma_f32_16x16x32_bf16 v[216:219], v[14:17], v[76:79], v[216:219]
    v_mfma_f32_16x16x32_bf16 v[220:223], v[14:17], v[80:83], v[220:223]
.Ls_28:
    v_mov_b32 v26, 0x3727c5ac
    s_lshl_b32 s36, s3, 8
    s_add_u32 s36, s36, 155648
    v_lshl_add_u32 v27, v2, 4, s36
    s_add_u32 s36, s36, 2048
    v_lshl_add_u32 v28, v3, 4, s36
    v_lshl_add_u32 v29, v2, 2, s36
    s_mov_b32 exec_lo, 0x00010001
    s_mov_b32 exec_hi, 0x00010001
    ds_write_b128 v28, v[116:119] offset:0
    ds_write_b128 v28, v[120:123] offset:128
    s_mov_b32 exec_lo, 0x00100001
    s_mov_b32 exec_hi, 0x10000100
    ds_write2_b32 v29, v124, v128 offset0:16 offset1:48
    s_lshl_b64 exec, exec, 1
    ds_write2_b32 v29, v125, v129 offset0:16 offset1:48
    s_lshl_b64 exec, exec, 1
    ds_write2_b32 v29, v126, v130 offset0:16 offset1:48
    s_lshl_b64 exec, exec, 1
    ds_write2_b32 v29, v127, v131 offset0:16 offset1:48
    s_mov_b64 exec, 0x0000ffff
    ds_write2_b32 v27, v208, v212 offset0:0 offset1:1
    ds_write2_b32 v27, v216, v220 offset0:2 offset1:3
    s_mov_b64 exec, -1
    v_and_b32 v6, 1, v3
    v_lshl_add_u32 v32, v6, 7, v29
    v_xor_b32 v33, 1024, v32
    s_lshl_b32 s36, s3, 9
    s_add_u32 s36, s36, 159744
    v_and_b32 v6, 31, v1
    v_lshl_add_u32 v29, v6, 2, s36
    v_lshl_add_u32 v28, v3, 4, s36
    v_and_b32 v27, 0xfffffcff, v27
    s_waitcnt vmcnt(0) lgkmcnt(0)
    s_barrier
    ds_read2_b32 v[36:37], v32 offset0:0 offset1:16
    ds_read2_b32 v[38:39], v33 offset0:0 offset1:16
    ds_read_b128 v[208:211], v27 offset:0
    ds_read_b128 v[212:215], v27 offset:256
    ds_read_b128 v[216:219], v27 offset:512
    ds_read_b128 v[220:223], v27 offset:768
    s_mul_i32 s52, s50, 229376
    s_add_u32 s52, s52, s51
    s_add_u32 s50, s50, 1
    s_cmp_eq_u32 s50, 7
    s_cselect_b32 s50, 0, s50
    s_add_u32 m0, s53, 65536
    s_nop 0
    buffer_load_dwordx4 v10, s[20:23], s52 offen offset:0 lds
    s_waitcnt lgkmcnt(4)
    v_pk_add_f32 v[36:37], v[36:37], v[38:39]
    v_mul_f32 v36, s55, v36
    v_fma_f32 v37, v37, s55, v26
    v_fma_f32 v37, -v36, v36, v37
    v_max_f32 v37, v37, v26
    v_rsq_f32 v37, v37
    s_nop 0
    v_mul_f32 v38, s56, v37
    ds_write2_b32 v29, v36, v37 offset0:0 offset1:32
    ds_write_b32 v29, v38 offset:256
    ds_read_b128 v[116:119], v28 offset:0
    ds_read_b128 v[120:123], v28 offset:64
    ds_read_b128 v[124:127], v28 offset:128
    ds_read_b128 v[128:131], v28 offset:192
    ds_read_b128 v[44:47], v28 offset:256
    ds_read_b128 v[48:51], v28 offset:320
    ds_read_b64_tr_b16 v[160:161], v12 offset:0
    ds_read_b64_tr_b16 v[162:163], v12 offset:1024
    ds_read_b64_tr_b16 v[164:165], v12 offset:8192
    ds_read_b64_tr_b16 v[166:167], v12 offset:9216
    ds_read_b64_tr_b16 v[168:169], v12 offset:16384
    ds_read_b64_tr_b16 v[170:171], v12 offset:17408
    ds_read_b64_tr_b16 v[172:173], v12 offset:24576
    ds_read_b64_tr_b16 v[174:175], v12 offset:25600
    s_add_u32 s52, s52, 27648
    buffer_load_dwordx4 v10, s[20:23], s52 offen offset:1024 lds
    s_lshl_b32 s36, s62, 14
    s_and_b32 s37, s3, 3
    s_lshl_b32 s37, s37, 10
    s_add_u32 s36, s36, s37
    v_add_u32 v30, s36, v4
    s_mov_b32 s60, 0xf000f000
    s_mov_b32 s61, 0xf000f000
    s_bitcmp1_b32 s3, 1
    s_cselect_b64 vcc, -1, 0
    v_lshrrev_b32 v6, 2, v1
    v_sub_u32 v7, v6, v3
    v_cndmask_b32 v7, v7, 12, s[60:61]
    v_cndmask_b32 v6, v6, v7, vcc
    v_and_b32 v7, 3, v1
    v_lshl_add_u32 v6, v6, 2, v7
    v_lshl_add_u32 v31, v6, 2, s53
    s_add_u32 s52, s52, 27648
    buffer_load_dwordx4 v10, s[20:23], s52 offen offset:2048 lds
    s_waitcnt lgkmcnt(15)
    v_pk_add_f32 v[208:209], v[208:209], v[212:213]
    v_pk_add_f32 v[216:217], v[216:217], v[220:221]
    v_pk_add_f32 v[210:211], v[210:211], v[214:215]
    v_pk_add_f32 v[218:219], v[218:219], v[222:223]
    v_pk_add_f32 v[208:209], v[208:209], v[216:217]
    v_pk_add_f32 v[210:211], v[210:211], v[218:219]
    s_add_u32 s52, s52, 27648
    buffer_load_dwordx4 v10, s[20:23], s52 offen offset:3072 lds
    s_waitcnt lgkmcnt(8)
    s_mul_i32 s52, s50, 229376
    s_add_u32 s52, s52, s51
    s_add_u32 s50, s50, 1
    s_cmp_eq_u32 s50, 7
    s_cselect_b32 s50, 0, s50
    s_add_u32 m0, s53, 32768
    s_nop 0
    buffer_load_dwordx4 v10, s[20:23], s52 offen offset:0 lds
    ds_read_b64_tr_b16 v[136:137], v132 offset:0
    ds_read_b64_tr_b16 v[138:139], v134 offset:0
    v_pk_fma_f32 v[84:85], v[208:209], v[116:117], v[84:85] op_sel:[0,0,0] op_sel_hi:[0,1,1] neg_lo:[1,0,0] neg_hi:[1,0,0]
    v_pk_fma_f32 v[86:87], v[208:209], v[118:119], v[86:87] op_sel:[0,0,0] op_sel_hi:[0,1,1] neg_lo:[1,0,0] neg_hi:[1,0,0]
    v_pk_fma_f32 v[100:101], v[208:209], v[120:121], v[100:101] op_sel:[0,0,0] op_sel_hi:[0,1,1] neg_lo:[1,0,0] neg_hi:[1,0,0]
    v_pk_fma_f32 v[102:103], v[208:209], v[122:123], v[102:103] op_sel:[0,0,0] op_sel_hi:[0,1,1] neg_lo:[1,0,0] neg_hi:[1,0,0]
    s_add_u32 s52, s52, 27648
    buffer_load_dwordx4 v10, s[20:23], s52 offen offset:1024 lds
    ds_read_b64_tr_b16 v[140:141], v133 offset:3584
    ds_read_b64_tr_b16 v[142:143], v135 offset:3584
    v_pk_fma_f32 v[88:89], v[208:209], v[116:117], v[88:89] op_sel:[1,0,0] op_sel_hi:[1,1,1] neg_lo:[1,0,0] neg_hi:[1,0,0]
    v_pk_fma_f32 v[90:91], v[208:209], v[118:119], v[90:91] op_sel:[1,0,0] op_sel_hi:[1,1,1] neg_lo:[1,0,0] neg_hi:[1,0,0]
    v_pk_fma_f32 v[104:105], v[208:209], v[120:121], v[104:105] op_sel:[1,0,0] op_sel_hi:[1,1,1] neg_lo:[1,0,0] neg_hi:[1,0,0]
    v_pk_fma_f32 v[106:107], v[208:209], v[122:123], v[106:107] op_sel:[1,0,0] op_sel_hi:[1,1,1] neg_lo:[1,0,0] neg_hi:[1,0,0]
    s_add_u32 s52, s52, 27648
    buffer_load_dwordx4 v10, s[20:23], s52 offen offset:2048 lds
    ds_read_b64_tr_b16 v[52:53], v132 offset:7168
    ds_read_b64_tr_b16 v[54:55], v134 offset:7168
    v_pk_fma_f32 v[92:93], v[210:211], v[116:117], v[92:93] op_sel:[0,0,0] op_sel_hi:[0,1,1] neg_lo:[1,0,0] neg_hi:[1,0,0]
    v_pk_fma_f32 v[94:95], v[210:211], v[118:119], v[94:95] op_sel:[0,0,0] op_sel_hi:[0,1,1] neg_lo:[1,0,0] neg_hi:[1,0,0]
    v_pk_fma_f32 v[108:109], v[210:211], v[120:121], v[108:109] op_sel:[0,0,0] op_sel_hi:[0,1,1] neg_lo:[1,0,0] neg_hi:[1,0,0]
    v_pk_fma_f32 v[110:111], v[210:211], v[122:123], v[110:111] op_sel:[0,0,0] op_sel_hi:[0,1,1] neg_lo:[1,0,0] neg_hi:[1,0,0]
    s_add_u32 s52, s52, 27648
    buffer_load_dwordx4 v10, s[20:23], s52 offen offset:3072 lds
    ds_read_b64_tr_b16 v[56:57], v133 offset:10752
    ds_read_b64_tr_b16 v[58:59], v135 offset:10752
    v_pk_fma_f32 v[96:97], v[210:211], v[116:117], v[96:97] op_sel:[1,0,0] op_sel_hi:[1,1,1] neg_lo:[1,0,0] neg_hi:[1,0,0]
    v_pk_fma_f32 v[98:99], v[210:211], v[118:119], v[98:99] op_sel:[1,0,0] op_sel_hi:[1,1,1] neg_lo:[1,0,0] neg_hi:[1,0,0]
    v_pk_fma_f32 v[112:113], v[210:211], v[120:121], v[112:113] op_sel:[1,0,0] op_sel_hi:[1,1,1] neg_lo:[1,0,0] neg_hi:[1,0,0]
    v_pk_fma_f32 v[114:115], v[210:211], v[122:123], v[114:115] op_sel:[1,0,0] op_sel_hi:[1,1,1] neg_lo:[1,0,0] neg_hi:[1,0,0]
    ds_read_b64_tr_b16 v[60:61], v132 offset:14336
    ds_read_b64_tr_b16 v[62:63], v134 offset:14336
    v_pk_mul_f32 v[36:37], v[44:45], v[84:85] op_sel:[0,0] op_sel_hi:[1,1]
    v_pk_fma_f32 v[84:85], v[124:125], v[84:85], s[58:59] op_sel:[0,0,0] op_sel_hi:[1,1,1]
    v_exp_f32 v36, v36 clamp
    v_exp_f32 v37, v37 clamp
    v_max_f32 v84, s58, v84
    v_max_f32 v85, s58, v85
    v_pk_add_f32 v[84:85], v[84:85], v[36:37]
    v_cvt_pk_bf16_f32 v68, v84, v85
    v_pk_mul_f32 v[38:39], v[46:47], v[86:87] op_sel:[0,0] op_sel_hi:[1,1]
    v_pk_fma_f32 v[86:87], v[126:127], v[86:87], s[58:59] op_sel:[0,0,0] op_sel_hi:[1,1,1]
    v_exp_f32 v38, v38 clamp
    v_exp_f32 v39, v39 clamp
    v_max_f32 v86, s58, v86
    v_max_f32 v87, s58, v87
    v_pk_add_f32 v[86:87], v[86:87], v[38:39]
    v_cvt_pk_bf16_f32 v69, v86, v87
    s_lshl3_add_u32 s41, s4, s3
    s_lshl_b32 s41, s41, 7
    s_add_u32 s41, s41, 32772
    s_mov_b64 exec, 0x00000001
    buffer_load_dword v0, off, s[32:35], s41 sc1
    s_mov_b64 exec, -1
    ds_read_b64_tr_b16 v[64:65], v133 offset:17920
    ds_read_b64_tr_b16 v[66:67], v135 offset:17920
    v_pk_mul_f32 v[40:41], v[48:49], v[100:101] op_sel:[0,0] op_sel_hi:[1,1]
    v_pk_fma_f32 v[100:101], v[128:129], v[100:101], s[58:59] op_sel:[0,0,0] op_sel_hi:[1,1,1]
    v_exp_f32 v40, v40 clamp
    v_exp_f32 v41, v41 clamp
    v_max_f32 v100, s58, v100
    v_max_f32 v101, s58, v101
    v_pk_add_f32 v[100:101], v[100:101], v[40:41]
    v_cvt_pk_bf16_f32 v70, v100, v101
    v_pk_mul_f32 v[42:43], v[50:51], v[102:103] op_sel:[0,0] op_sel_hi:[1,1]
    v_pk_fma_f32 v[102:103], v[130:131], v[102:103], s[58:59] op_sel:[0,0,0] op_sel_hi:[1,1,1]
    v_exp_f32 v42, v42 clamp
    v_exp_f32 v43, v43 clamp
    v_max_f32 v102, s58, v102
    v_max_f32 v103, s58, v103
    v_pk_add_f32 v[102:103], v[102:103], v[42:43]
    v_cvt_pk_bf16_f32 v71, v102, v103
    ds_read_b64_tr_b16 v[116:117], v132 offset:21504
    ds_read_b64_tr_b16 v[118:119], v134 offset:21504
    v_pk_mul_f32 v[36:37], v[44:45], v[88:89] op_sel:[0,0] op_sel_hi:[1,1]
    v_pk_fma_f32 v[88:89], v[124:125], v[88:89], s[58:59] op_sel:[0,0,0] op_sel_hi:[1,1,1]
    v_exp_f32 v36, v36 clamp
    v_exp_f32 v37, v37 clamp
    v_max_f32 v88, s58, v88
    v_max_f32 v89, s58, v89
    v_pk_add_f32 v[88:89], v[88:89], v[36:37]
    v_cvt_pk_bf16_f32 v72, v88, v89
    v_pk_mul_f32 v[38:39], v[46:47], v[90:91] op_sel:[0,0] op_sel_hi:[1,1]
    v_pk_fma_f32 v[90:91], v[126:127], v[90:91], s[58:59] op_sel:[0,0,0] op_sel_hi:[1,1,1]
    v_exp_f32 v38, v38 clamp
    v_exp_f32 v39, v39 clamp
    v_max_f32 v90, s58, v90
    v_max_f32 v91, s58, v91
    v_pk_add_f32 v[90:91], v[90:91], v[38:39]
    v_cvt_pk_bf16_f32 v73, v90, v91
    ds_read_b64_tr_b16 v[120:121], v133 offset:25088
    ds_read_b64_tr_b16 v[122:123], v135 offset:25088
    v_pk_mul_f32 v[40:41], v[48:49], v[104:105] op_sel:[0,0] op_sel_hi:[1,1]
    v_pk_fma_f32 v[104:105], v[128:129], v[104:105], s[58:59] op_sel:[0,0,0] op_sel_hi:[1,1,1]
    v_exp_f32 v40, v40 clamp
    v_exp_f32 v41, v41 clamp
    v_max_f32 v104, s58, v104
    v_max_f32 v105, s58, v105
    v_pk_add_f32 v[104:105], v[104:105], v[40:41]
    v_cvt_pk_bf16_f32 v74, v104, v105
    v_pk_mul_f32 v[42:43], v[50:51], v[106:107] op_sel:[0,0] op_sel_hi:[1,1]
    v_pk_fma_f32 v[106:107], v[130:131], v[106:107], s[58:59] op_sel:[0,0,0] op_sel_hi:[1,1,1]
    v_exp_f32 v42, v42 clamp
    v_exp_f32 v43, v43 clamp
    v_max_f32 v106, s58, v106
    v_max_f32 v107, s58, v107
    v_pk_add_f32 v[106:107], v[106:107], v[42:43]
    v_cvt_pk_bf16_f32 v75, v106, v107
    s_lshl1_add_u32 s46, s4, s40
    s_lshl_b32 s46, s46, 2
    s_lshl3_add_u32 s38, s46, s3
    s_lshl_b32 s38, s38, 11
    s_add_u32 s38, s38, 1048576
    s_waitcnt vmcnt(0)
    s_mov_b64 exec, 0x00000001
.Lpw_29:
    v_cmp_ne_u32 vcc, v0, v5
    s_and_b64 exec, exec, vcc
    s_cbranch_scc0 .Lpd_30
    buffer_load_dword v0, off, s[32:35], s41 sc1
    s_sub_u32 s48, s48, 1
    s_waitcnt vmcnt(0)
    s_cbranch_scc0 .Lpw_29
    s_mov_b32 s48, 0
.Lpd_30:
    s_mov_b64 exec, -1
    buffer_load_dwordx4 v[224:227], v4, s[32:35], s38 offen offset:0 sc1
    ds_read_b64_tr_b16 v[36:37], v132 offset:28672
    ds_read_b64_tr_b16 v[38:39], v134 offset:28672
    v_pk_mul_f32 v[92:93], v[92:93], v[124:125]
    v_cvt_pk_bf16_f32 v76, v92, v93
    v_pk_mul_f32 v[94:95], v[94:95], v[126:127]
    v_cvt_pk_bf16_f32 v77, v94, v95
    buffer_load_dwordx4 v[228:231], v4, s[32:35], s38 offen offset:1024 sc1
    s_add_u32 s38, s38, 16384
    ds_read_b64_tr_b16 v[40:41], v133 offset:32256
    ds_read_b64_tr_b16 v[42:43], v135 offset:32256
    v_pk_mul_f32 v[108:109], v[108:109], v[128:129]
    v_cvt_pk_bf16_f32 v78, v108, v109
    v_pk_mul_f32 v[110:111], v[110:111], v[130:131]
    v_cvt_pk_bf16_f32 v79, v110, v111
    buffer_load_dwordx4 v[232:235], v4, s[32:35], s38 offen offset:0 sc1
    ds_read_b64_tr_b16 v[44:45], v132 offset:35840
    ds_read_b64_tr_b16 v[46:47], v134 offset:35840
    v_pk_mul_f32 v[96:97], v[96:97], v[124:125]
    v_cvt_pk_bf16_f32 v80, v96, v97
    v_pk_mul_f32 v[98:99], v[98:99], v[126:127]
    v_cvt_pk_bf16_f32 v81, v98, v99
    buffer_load_dwordx4 v[236:239], v4, s[32:35], s38 offen offset:1024 sc1
    s_add_u32 s38, s38, 16384
    ds_read_b64_tr_b16 v[48:49], v133 offset:39424
    ds_read_b64_tr_b16 v[50:51], v135 offset:39424
    v_pk_mul_f32 v[112:113], v[112:113], v[128:129]
    v_cvt_pk_bf16_f32 v82, v112, v113
    v_pk_mul_f32 v[114:115], v[114:115], v[130:131]
    v_cvt_pk_bf16_f32 v83, v114, v115
    v_cndmask_b32 v80, v80, v14, s[60:61]
    v_cndmask_b32 v81, v81, v14, s[60:61]
    v_cndmask_b32 v82, v82, v14, s[60:61]
    v_cndmask_b32 v83, v83, v14, s[60:61]
    s_waitcnt lgkmcnt(15)
    s_barrier
    v_mfma_f32_16x16x32_bf16 v[84:87], v[68:71], v[76:79], 0
    buffer_load_dwordx4 v[240:243], v4, s[32:35], s38 offen offset:0 sc1
    v_mfma_f32_16x16x32_bf16 v[88:91], v[72:75], v[76:79], 0
    buffer_load_dwordx4 v[244:247], v4, s[32:35], s38 offen offset:1024 sc1
    s_add_u32 s38, s38, 16384
    v_mfma_f32_16x16x32_bf16 v[92:95], v[68:71], v[80:83], 0
    buffer_load_dwordx4 v[248:251], v4, s[32:35], s38 offen offset:0 sc1
    v_mfma_f32_16x16x32_bf16 v[96:99], v[72:75], v[80:83], 0
    buffer_load_dwordx4 v[252:255], v4, s[32:35], s38 offen offset:1024 sc1
    s_lshl_b32 s36, s5, 13
    s_lshl_b32 s37, s3, 10
    s_add_u32 s36, s36, s37
    s_add_u32 s36, s36, 131072
    s_lshl4_add_u32 s54, s5, s4
    s_lshl_b32 s54, s54, 7
    s_add_u32 s54, s54, 262144
    v_lshlrev_b32 v27, 2, v1
    ds_write_b128 v30, v[84:87] offset:0
    ds_write_b128 v30, v[88:91] offset:4096
    ds_write_b128 v30, v[92:95] offset:8192
    ds_write_b128 v30, v[96:99] offset:12288
    ds_read_b64_tr_b16 v[124:125], v132 offset:43008
    ds_read_b64_tr_b16 v[126:127], v134 offset:43008
    ds_read_b64_tr_b16 v[128:129], v133 offset:46592
    ds_read_b64_tr_b16 v[130:131], v135 offset:46592
    s_waitcnt lgkmcnt(4)
    s_barrier
    ds_read2st64_b32 v[100:101], v31 offset0:0 offset1:1
    ds_read2st64_b32 v[102:103], v31 offset0:2 offset1:3
    ds_read2st64_b32 v[104:105], v31 offset0:4 offset1:5
    ds_read2st64_b32 v[106:107], v31 offset0:6 offset1:7
    ds_read2st64_b32 v[108:109], v31 offset0:8 offset1:9
    ds_read2st64_b32 v[110:111], v31 offset0:10 offset1:11
    ds_read2st64_b32 v[112:113], v31 offset0:12 offset1:13
    ds_read2st64_b32 v[114:115], v31 offset0:14 offset1:15
    s_mov_b64 exec, 0x00000001
.Lpw_31:
    v_cmp_ne_u32 vcc, v34, v5
    s_and_b64 exec, exec, vcc
    s_cbranch_scc0 .Lpd_32
    buffer_load_dword v34, off, s[32:35], s44 offset:1028 sc1
    s_sub_u32 s48, s48, 1
    s_waitcnt vmcnt(0)
    s_cbranch_scc0 .Lpw_31
    s_mov_b32 s48, 0
.Lpd_32:
    s_mov_b64 exec, -1
    s_waitcnt lgkmcnt(0)
    v_pk_add_f32 v[100:101], v[100:101], v[104:105]
    v_pk_add_f32 v[108:109], v[108:109], v[112:113]
    v_pk_add_f32 v[102:103], v[102:103], v[106:107]
    v_pk_add_f32 v[110:111], v[110:111], v[114:115]
    v_pk_add_f32 v[100:101], v[100:101], v[108:109]
    v_pk_add_f32 v[102:103], v[102:103], v[110:111]
    s_bitcmp1_b32 s3, 0
    buffer_atomic_add_f32 v100, v27, s[32:35], s36 offen offset:0
    buffer_atomic_add_f32 v101, v27, s[32:35], s36 offen offset:256
    buffer_atomic_add_f32 v102, v27, s[32:35], s36 offen offset:512
    s_cbranch_scc1 .Lat
    buffer_atomic_add_f32 v103, v27, s[32:35], s36 offen offset:768
.Lat:
    ds_read_b64_tr_b16 v[176:177], v13 offset:0
    ds_read_b64_tr_b16 v[178:179], v13 offset:1024
    ds_read_b64_tr_b16 v[180:181], v13 offset:8192
    ds_read_b64_tr_b16 v[182:183], v13 offset:9216
    ds_read_b64_tr_b16 v[184:185], v13 offset:16384
    ds_read_b64_tr_b16 v[186:187], v13 offset:17408
    ds_read_b64_tr_b16 v[188:189], v13 offset:24576
    ds_read_b64_tr_b16 v[190:191], v13 offset:25600
    ds_read_b64_tr_b16 v[192:193], v12 offset:32768
    ds_read_b64_tr_b16 v[194:195], v12 offset:33792
    ds_read_b64_tr_b16 v[196:197], v12 offset:40960
    ds_read_b64_tr_b16 v[198:199], v12 offset:41984
    ds_read_b64_tr_b16 v[200:201], v12 offset:49152
    ds_read_b64_tr_b16 v[202:203], v12 offset:50176
    ds_read_b64_tr_b16 v[204:205], v12 offset:57344
    ds_read_b64_tr_b16 v[206:207], v12 offset:58368
    ds_read_b64_tr_b16 v[68:69], v132 offset:50176
    ds_read_b64_tr_b16 v[70:71], v134 offset:50176
    ds_read_b64_tr_b16 v[72:73], v133 offset:53760
    ds_read_b64_tr_b16 v[74:75], v135 offset:53760
    s_branch .Ljoin
.Lq:
    s_lshr_b32 s36, s3, 1
    s_mul_i32 s36, s36, 43008
    s_add_u32 s43, s43, s36
    s_and_b32 s36, s3, 4
    s_add_u32 s36, s36, s3
    s_lshl_b32 s47, s36, 10
    s_add_u32 s47, s47, 16384
    s_bitcmp1_b32 s3, 0
    s_cselect_b64 vcc, -1, 0
    v_add_u32 v29, 1024, v29
    v_cndmask_b32 v28, v28, v29, vcc
    s_waitcnt lgkmcnt(0)
    s_lshl_b32 s44, s41, 7
    s_add_u32 m0, s46, 0
    s_add_u32 s44, s44, s42
    buffer_load_dwordx4 v26, s[8:11], s44 offen lds
    buffer_load_dwordx4 v27, s[8:11], s44 offen offset:1024 lds
    s_mul_i32 s45, s41, 172032
    s_add_u32 m0, s47, 0
    s_add_u32 s45, s45, s43
    buffer_load_dwordx4 v28, s[12:15], s45 offen lds
    s_add_u32 s41, s41, 1
    s_cmp_eq_u32 s41, 7
    s_cselect_b32 s41, 0, s41
    s_lshl_b32 s36, s5, 1
    s_cmp_eq_u32 s36, s4
    s_cbranch_scc0 .Lz_33
    v_mov_b32 v84, 0
    v_mov_b32 v85, 0
    v_mov_b32 v86, 0
    v_mov_b32 v87, 0
    v_lshlrev_b32 v6, 4, v0
    s_lshl_b32 s36, s5, 13
    s_add_u32 s36, s36, 131072
    buffer_store_dwordx4 v[84:87], v6, s[32:35], s36 offen sc1
.Lz_33:
    buffer_load_dword v5, off, s[32:35], 0 sc1
    s_lshl_b32 s44, s41, 7
    s_add_u32 m0, s46, 32768
    s_add_u32 s44, s44, s42
    buffer_load_dwordx4 v26, s[8:11], s44 offen lds
    buffer_load_dwordx4 v27, s[8:11], s44 offen offset:1024 lds
    s_mul_i32 s45, s41, 172032
    s_add_u32 m0, s47, 32768
    s_add_u32 s45, s45, s43
    buffer_load_dwordx4 v28, s[12:15], s45 offen lds
    s_add_u32 s41, s41, 1
    s_cmp_eq_u32 s41, 7
    s_cselect_b32 s41, 0, s41
    s_lshl_b32 s44, s41, 7
    s_add_u32 m0, s46, 65536
    s_add_u32 s44, s44, s42
    buffer_load_dwordx4 v26, s[8:11], s44 offen lds
    buffer_load_dwordx4 v27, s[8:11], s44 offen offset:1024 lds
    s_mul_i32 s45, s41, 172032
    s_add_u32 m0, s47, 65536
    s_add_u32 s45, s45, s43
    buffer_load_dwordx4 v28, s[12:15], s45 offen lds
    s_add_u32 s41, s41, 1
    s_cmp_eq_u32 s41, 7
    s_cselect_b32 s41, 0, s41
    s_load_dwordx2 s[16:17], s[0:1], 16
    s_load_dwordx4 s[36:39], s[0:1], 32
    s_load_dwordx2 s[24:25], s[0:1], 48
    s_load_dwordx2 s[28:29], s[0:1], 56
    v_and_b32 v2, 15, v1
    v_lshlrev_b32 v4, 4, v1
    s_mov_b32 s18, 0x00062000
    s_mov_b32 s19, 0x00020000
    s_mov_b32 s22, 0x00188000
    s_mov_b32 s23, 0x00020000
    s_mov_b32 s26, 0x00188000
    s_mov_b32 s27, 0x00020000
    s_mov_b32 s30, 0x001c0000
    s_mov_b32 s31, 0x00020000
    s_sub_u32 s6, 13, s49
    s_cmp_ge_u32 s2, 128
    s_cselect_b32 s6, s6, s49
    s_cmp_ge_u32 s49, 14
    s_cselect_b32 s6, s5, s6
    s_cmp_ge_u32 s6, 7
    s_cselect_b32 s40, 1, 0
    s_mul_i32 s7, s40, 7
    s_sub_u32 s7, s6, s7
    s_and_b32 s57, s2, 7
    s_cmp_eq_u32 s57, 7
    s_cselect_b32 s57, 0, s57
    s_mov_b32 s50, s57
    s_lshl_b32 s53, s3, 12
    s_mov_b32 s48, 0x20000
    s_lshr_b32 s62, s3, 2
    s_mul_i32 s51, s62, 114688
    s_and_b32 s63, s3, 1
    s_lshl1_add_u32 s63, s6, s63
    s_lshl_b32 s63, s63, 7
    s_add_u32 s51, s51, s63
    s_and_b32 s63, s3, 3
    s_lshl_b32 s52, s62, 1
    s_xor_b32 s63, s63, s52
    v_lshrrev_b32 v6, 3, v1
    v_and_b32 v7, 6, v6
    v_xor_b32 v7, v7, v1
    v_and_b32 v7, 7, v7
    v_lshlrev_b32 v7, 4, v7
    v_mul_u32_u24 v8, 3584, v6
    v_add_u32 v10, v7, v8
    v_mul_u32_u24 v8, 896, v6
    v_add_u32 v11, v7, v8
    v_lshrrev_b32 v7, 1, v2
    v_xor_b32 v7, v7, v3
    v_lshlrev_b32 v7, 4, v7
    v_lshl_add_u32 v7, v2, 7, v7
    s_and_b32 s52, s53, 0x3000
    v_add_u32 v30, s52, v7
    v_xor_b32 v31, 64, v30
    v_and_b32 v6, 3, v6
    v_lshrrev_b32 v7, 2, v2
    v_lshl_add_u32 v7, v3, 3, v7
    v_lshlrev_b32 v7, 7, v7
    s_mul_i32 s52, s62, 7
    v_and_b32 v8, 3, v1
    v_add_u32 v8, s52, v8
    v_and_b32 v9, 3, v8
    v_lshl_add_u32 v7, v9, 3, v7
    v_add_u32 v7, 16384, v7
    v_lshrrev_b32 v8, 2, v8
    v_xor_b32 v9, v8, v6
    v_lshl_add_u32 v32, v9, 5, v7
    v_add_u32 v8, 1, v8
    v_xor_b32 v9, v8, v6
    v_lshl_add_u32 v33, v9, 5, v7
    s_and_b32 s52, s3, 3
    v_xor_b32 v6, s52, v6
    v_lshrrev_b32 v7, 2, v1
    v_lshlrev_b32 v7, 7, v7
    v_lshl_add_u32 v7, v6, 5, v7
    v_and_b32 v8, 3, v1
    v_lshl_add_u32 v7, v8, 3, v7
    v_and_b32 v8, 32, v1
    v_lshl_add_u32 v7, v8, 5, v7
    s_lshl_b32 s52, s62, 12
    v_add_u32 v12, s52, v7
    v_add_u32 v13, 65536, v12
    s_and_b32 s52, s3, 3
    v_and_b32 v8, 3, v1
    v_lshlrev_b32 v8, 3, v8
    v_add_u32 v8, 98304, v8
    v_lshrrev_b32 v6, 2, v1
    v_lshrrev_b32 v7, 2, v2
    v_min_u32 v7, 2, v7
    v_mad_u32_u24 v7, v3, 3, v7
    v_add_u32 v7, 16, v7
    v_bfe_u32 v9, v6, 1, 2
    v_xor_b32 v9, s52, v9
    v_lshl_add_u32 v9, v9, 5, v8
    v_lshl_add_u32 v132, v6, 7, v9
    v_xor_b32 v133, 64, v132
    v_bfe_u32 v9, v7, 1, 2
    v_xor_b32 v9, s52, v9
    v_lshl_add_u32 v9, v9, 5, v8
    v_lshl_add_u32 v134, v7, 7, v9
    v_xor_b32 v135, 64, v134
    v_mov_b32 v14, 0x3f803f80
    v_mov_b32 v15, 0x3f803f80
    v_mov_b32 v16, 0x3f803f80
    v_mov_b32 v17, 0x3f803f80
    s_mov_b32 s55, 0x3b124925
    s_mov_b32 s56, 0x3fb8aa3b
    s_mov_b32 s58, 0x358637bd
    s_mov_b32 s59, 0x358637bd
    s_bitcmp1_b32 s3, 1
    s_waitcnt lgkmcnt(0)
    s_cselect_b32 s20, s38, s36
    s_cselect_b32 s21, s39, s37
    s_waitcnt vmcnt(7)
    s_barrier
    ds_read_b128 v[36:39], v30 offset:0
    ds_read_b128 v[40:43], v30 offset:2048
    ds_read_b64_tr_b16 v[52:53], v32 offset:0
    ds_read_b64_tr_b16 v[54:55], v32 offset:512
    ds_read_b64_tr_b16 v[56:57], v33 offset:0
    ds_read_b64_tr_b16 v[58:59], v33 offset:512
    s_waitcnt lgkmcnt(0)
    v_mfma_f32_16x16x32_bf16 v[84:87], v[52:55], v[36:39], 0
    ds_read_b128 v[44:47], v31 offset:0
    ds_read_b128 v[48:51], v31 offset:2048
    v_mfma_f32_16x16x32_bf16 v[100:103], v[52:55], v[40:43], 0
    ds_read_b64_tr_b16 v[68:69], v32 offset:8192
    ds_read_b64_tr_b16 v[70:71], v32 offset:8704
    s_lshl_b32 s44, s41, 7
    s_add_u32 m0, s46, 98304
    s_add_u32 s44, s44, s42
    buffer_load_dwordx4 v26, s[8:11], s44 offen lds
    v_mfma_f32_16x16x32_bf16 v[88:91], v[56:59], v[36:39], 0
    ds_read_b64_tr_b16 v[72:73], v33 offset:8192
    v_mfma_f32_16x16x32_bf16 v[104:107], v[56:59], v[40:43], 0
    ds_read_b64_tr_b16 v[74:75], v33 offset:8704
    buffer_load_dwordx4 v27, s[8:11], s44 offen offset:1024 lds
    v_mfma_f32_16x16x32_bf16 v[116:119], v[14:17], v[36:39], 0
    v_mfma_f32_16x16x32_bf16 v[124:127], v[36:39], v[36:39], 0
    s_mul_i32 s45, s41, 172032
    s_add_u32 m0, s47, 98304
    s_add_u32 s45, s45, s43
    buffer_load_dwordx4 v28, s[12:15], s45 offen lds
    s_add_u32 s41, s41, 1
    s_cmp_eq_u32 s41, 7
    s_cselect_b32 s41, 0, s41
    v_mfma_f32_16x16x32_bf16 v[120:123], v[14:17], v[40:43], 0
    v_mfma_f32_16x16x32_bf16 v[128:131], v[40:43], v[40:43], 0
    v_mfma_f32_16x16x32_bf16 v[208:211], v[52:55], v[14:17], 0
    v_mfma_f32_16x16x32_bf16 v[212:215], v[56:59], v[14:17], 0
    s_waitcnt vmcnt(6) lgkmcnt(0)
    s_barrier
    v_add_u32 v5, 32, v5
    s_lshl_b32 s36, s5, 1
    s_cmp_eq_u32 s36, s4
    s_cbranch_scc0 .Lz_34
    s_lshl_b32 s36, s5, 7
    s_cmp_eq_u32 s3, 0
    s_cbranch_scc0 .Lfl_35
    s_mov_b64 exec, 0xff
    buffer_store_dwordx4 v[4:7], v4, s[32:35], s36 offen offset:1024 sc1
    s_mov_b64 exec, -1
.Lfl_35:
.Lz_34:
    v_mfma_f32_16x16x32_bf16 v[84:87], v[68:71], v[44:47], v[84:87]
    ds_read_b128 v[36:39], v30 offset:32768
    ds_read_b128 v[40:43], v30 offset:34816
    v_mfma_f32_16x16x32_bf16 v[100:103], v[68:71], v[48:51], v[100:103]
    ds_read_b64_tr_b16 v[52:53], v32 offset:32768
    ds_read_b64_tr_b16 v[54:55], v32 offset:33280
    s_lshl_b32 s44, s41, 7
    s_add_u32 m0, s46, 131072
    s_add_u32 s44, s44, s42
    buffer_load_dwordx4 v26, s[8:11], s44 offen lds
    v_mfma_f32_16x16x32_bf16 v[88:91], v[72:75], v[44:47], v[88:91]
    ds_read_b64_tr_b16 v[56:57], v33 offset:32768
    v_mfma_f32_16x16x32_bf16 v[104:107], v[72:75], v[48:51], v[104:107]
    ds_read_b64_tr_b16 v[58:59], v33 offset:33280
    buffer_load_dwordx4 v27, s[8:11], s44 offen offset:1024 lds
    v_mfma_f32_16x16x32_bf16 v[116:119], v[14:17], v[44:47], v[116:119]
    v_mfma_f32_16x16x32_bf16 v[124:127], v[44:47], v[44:47], v[124:127]
    s_mul_i32 s45, s41, 172032
    s_add_u32 m0, s47, 131072
    s_add_u32 s45, s45, s43
    buffer_load_dwordx4 v28, s[12:15], s45 offen lds
    s_add_u32 s41, s41, 1
    s_cmp_eq_u32 s41, 7
    s_cselect_b32 s41, 0, s41
    v_mfma_f32_16x16x32_bf16 v[120:123], v[14:17], v[48:51], v[120:123]
    v_mfma_f32_16x16x32_bf16 v[128:131], v[48:51], v[48:51], v[128:131]
    v_mfma_f32_16x16x32_bf16 v[208:211], v[68:71], v[14:17], v[208:211]
    v_mfma_f32_16x16x32_bf16 v[212:215], v[72:75], v[14:17], v[212:215]
    s_waitcnt lgkmcnt(0)
    v_mfma_f32_16x16x32_bf16 v[84:87], v[52:55], v[36:39], v[84:87]
    ds_read_b128 v[44:47], v31 offset:32768
    ds_read_b128 v[48:51], v31 offset:34816
    v_mfma_f32_16x16x32_bf16 v[100:103], v[52:55], v[40:43], v[100:103]
    ds_read_b64_tr_b16 v[68:69], v32 offset:40960
    ds_read_b64_tr_b16 v[70:71], v32 offset:41472
    v_mfma_f32_16x16x32_bf16 v[88:91], v[56:59], v[36:39], v[88:91]
    ds_read_b64_tr_b16 v[72:73], v33 offset:40960
    v_mfma_f32_16x16x32_bf16 v[104:107], v[56:59], v[40:43], v[104:107]
    ds_read_b64_tr_b16 v[74:75], v33 offset:41472
    v_mfma_f32_16x16x32_bf16 v[116:119], v[14:17], v[36:39], v[116:119]
    v_mfma_f32_16x16x32_bf16 v[124:127], v[36:39], v[36:39], v[124:127]
    v_mfma_f32_16x16x32_bf16 v[120:123], v[14:17], v[40:43], v[120:123]
    v_mfma_f32_16x16x32_bf16 v[128:131], v[40:43], v[40:43], v[128:131]
    v_mfma_f32_16x16x32_bf16 v[208:211], v[52:55], v[14:17], v[208:211]
    v_mfma_f32_16x16x32_bf16 v[212:215], v[56:59], v[14:17], v[212:215]
    s_waitcnt vmcnt(6) lgkmcnt(0)
    s_barrier
    v_add_u32 v30, 0x00010000, v30
    v_add_u32 v31, 0x00010000, v31
    v_add_u32 v32, 0x00010000, v32
    v_add_u32 v33, 0x00010000, v33
    v_mfma_f32_16x16x32_bf16 v[84:87], v[68:71], v[44:47], v[84:87]
    ds_read_b128 v[36:39], v30 offset:0
    ds_read_b128 v[40:43], v30 offset:2048
    v_mfma_f32_16x16x32_bf16 v[100:103], v[68:71], v[48:51], v[100:103]
    ds_read_b64_tr_b16 v[52:53], v32 offset:0
    ds_read_b64_tr_b16 v[54:55], v32 offset:512
    s_lshl_b32 s44, s41, 7
    s_add_u32 m0, s46, 0
    s_add_u32 s44, s44, s42
    buffer_load_dwordx4 v26, s[8:11], s44 offen lds
    v_mfma_f32_16x16x32_bf16 v[88:91], v[72:75], v[44:47], v[88:91]
    ds_read_b64_tr_b16 v[56:57], v33 offset:0
    v_mfma_f32_16x16x32_bf16 v[104:107], v[72:75], v[48:51], v[104:107]
    ds_read_b64_tr_b16 v[58:59], v33 offset:512
    buffer_load_dwordx4 v27, s[8:11], s44 offen offset:1024 lds
    v_mfma_f32_16x16x32_bf16 v[116:119], v[14:17], v[44:47], v[116:119]
    v_mfma_f32_16x16x32_bf16 v[124:127], v[44:47], v[44:47], v[124:127]
    s_mul_i32 s45, s41, 172032
    s_add_u32 m0, s47, 0
    s_add_u32 s45, s45, s43
    buffer_load_dwordx4 v28, s[12:15], s45 offen lds
    s_add_u32 s41, s41, 1
    s_cmp_eq_u32 s41, 7
    s_cselect_b32 s41, 0, s41
    v_mfma_f32_16x16x32_bf16 v[120:123], v[14:17], v[48:51], v[120:123]
    v_mfma_f32_16x16x32_bf16 v[128:131], v[48:51], v[48:51], v[128:131]
    v_mfma_f32_16x16x32_bf16 v[208:211], v[68:71], v[14:17], v[208:211]
    v_mfma_f32_16x16x32_bf16 v[212:215], v[72:75], v[14:17], v[212:215]
    s_waitcnt lgkmcnt(0)
    v_mfma_f32_16x16x32_bf16 v[84:87], v[52:55], v[36:39], v[84:87]
    ds_read_b128 v[44:47], v31 offset:0
    ds_read_b128 v[48:51], v31 offset:2048
    v_mfma_f32_16x16x32_bf16 v[100:103], v[52:55], v[40:43], v[100:103]
    ds_read_b64_tr_b16 v[68:69], v32 offset:8192
    ds_read_b64_tr_b16 v[70:71], v32 offset:8704
    s_lshl_b32 s44, s41, 7
    s_add_u32 m0, s46, 32768
    s_add_u32 s44, s44, s42
    buffer_load_dwordx4 v26, s[8:11], s44 offen lds
    v_mfma_f32_16x16x32_bf16 v[88:91], v[56:59], v[36:39], v[88:91]
    ds_read_b64_tr_b16 v[72:73], v33 offset:8192
    v_mfma_f32_16x16x32_bf16 v[104:107], v[56:59], v[40:43], v[104:107]
    ds_read_b64_tr_b16 v[74:75], v33 offset:8704
    buffer_load_dwordx4 v27, s[8:11], s44 offen offset:1024 lds
    v_mfma_f32_16x16x32_bf16 v[116:119], v[14:17], v[36:39], v[116:119]
    v_mfma_f32_16x16x32_bf16 v[124:127], v[36:39], v[36:39], v[124:127]
    s_mul_i32 s45, s41, 172032
    s_add_u32 m0, s47, 32768
    s_add_u32 s45, s45, s43
    buffer_load_dwordx4 v28, s[12:15], s45 offen lds
    v_mfma_f32_16x16x32_bf16 v[120:123], v[14:17], v[40:43], v[120:123]
    v_mfma_f32_16x16x32_bf16 v[128:131], v[40:43], v[40:43], v[128:131]
    v_mfma_f32_16x16x32_bf16 v[208:211], v[52:55], v[14:17], v[208:211]
    v_mfma_f32_16x16x32_bf16 v[212:215], v[56:59], v[14:17], v[212:215]
    s_waitcnt vmcnt(9) lgkmcnt(0)
    s_barrier
    v_mfma_f32_16x16x32_bf16 v[84:87], v[68:71], v[44:47], v[84:87]
    ds_read_b128 v[36:39], v30 offset:32768
    ds_read_b128 v[40:43], v30 offset:34816
    v_mfma_f32_16x16x32_bf16 v[100:103], v[68:71], v[48:51], v[100:103]
    ds_read_b64_tr_b16 v[52:53], v32 offset:32768
    ds_read_b64_tr_b16 v[54:55], v32 offset:33280
    s_mul_i32 s52, s50, 229376
    s_add_u32 s52, s52, s51
    s_add_u32 s50, s50, 1
    s_cmp_eq_u32 s50, 7
    s_cselect_b32 s50, 0, s50
    s_add_u32 m0, s53, 65536
    s_nop 0
    buffer_load_dwordx4 v10, s[20:23], s52 offen offset:0 lds
    v_mfma_f32_16x16x32_bf16 v[88:91], v[72:75], v[44:47], v[88:91]
    ds_read_b64_tr_b16 v[56:57], v33 offset:32768
    v_mfma_f32_16x16x32_bf16 v[104:107], v[72:75], v[48:51], v[104:107]
    ds_read_b64_tr_b16 v[58:59], v33 offset:33280
    s_add_u32 s52, s52, 27648
    buffer_load_dwordx4 v10, s[20:23], s52 offen offset:1024 lds
    v_mfma_f32_16x16x32_bf16 v[116:119], v[14:17], v[44:47], v[116:119]
    v_mfma_f32_16x16x32_bf16 v[124:127], v[44:47], v[44:47], v[124:127]
    s_add_u32 s52, s52, 27648
    buffer_load_dwordx4 v10, s[20:23], s52 offen offset:2048 lds
    v_mfma_f32_16x16x32_bf16 v[120:123], v[14:17], v[48:51], v[120:123]
    v_mfma_f32_16x16x32_bf16 v[128:131], v[48:51], v[48:51], v[128:131]
    s_add_u32 s52, s52, 27648
    buffer_load_dwordx4 v10, s[20:23], s52 offen offset:3072 lds
    v_mfma_f32_16x16x32_bf16 v[208:211], v[68:71], v[14:17], v[208:211]
    v_mfma_f32_16x16x32_bf16 v[212:215], v[72:75], v[14:17], v[212:215]
    s_waitcnt lgkmcnt(0)
    v_mfma_f32_16x16x32_bf16 v[84:87], v[52:55], v[36:39], v[84:87]
    ds_read_b128 v[44:47], v31 offset:32768
    ds_read_b128 v[48:51], v31 offset:34816
    v_mfma_f32_16x16x32_bf16 v[100:103], v[52:55], v[40:43], v[100:103]
    ds_read_b64_tr_b16 v[68:69], v32 offset:40960
    ds_read_b64_tr_b16 v[70:71], v32 offset:41472
    v_mfma_f32_16x16x32_bf16 v[88:91], v[56:59], v[36:39], v[88:91]
    ds_read_b64_tr_b16 v[72:73], v33 offset:40960
    v_mfma_f32_16x16x32_bf16 v[104:107], v[56:59], v[40:43], v[104:107]
    ds_read_b64_tr_b16 v[74:75], v33 offset:41472
    v_mfma_f32_16x16x32_bf16 v[116:119], v[14:17], v[36:39], v[116:119]
    v_mfma_f32_16x16x32_bf16 v[124:127], v[36:39], v[36:39], v[124:127]
    v_mfma_f32_16x16x32_bf16 v[120:123], v[14:17], v[40:43], v[120:123]
    v_mfma_f32_16x16x32_bf16 v[128:131], v[40:43], v[40:43], v[128:131]
    v_mfma_f32_16x16x32_bf16 v[208:211], v[52:55], v[14:17], v[208:211]
    v_mfma_f32_16x16x32_bf16 v[212:215], v[56:59], v[14:17], v[212:215]
    s_waitcnt vmcnt(10) lgkmcnt(0)
    s_barrier
    v_add_u32 v30, 0x00010000, v30
    v_add_u32 v31, 0x00010000, v31
    v_add_u32 v32, 0x00010000, v32
    v_add_u32 v33, 0x00010000, v33
    v_mfma_f32_16x16x32_bf16 v[84:87], v[68:71], v[44:47], v[84:87]
    ds_read_b128 v[36:39], v30 offset:0
    ds_read_b128 v[40:43], v30 offset:2048
    v_mfma_f32_16x16x32_bf16 v[100:103], v[68:71], v[48:51], v[100:103]
    ds_read_b64_tr_b16 v[52:53], v32 offset:0
    ds_read_b64_tr_b16 v[54:55], v32 offset:512
    s_mul_i32 s45, s3, 28672
    s_lshl_b32 s41, s7, 7
    s_add_u32 s45, s45, s41
    s_add_u32 m0, s53, 98304
    s_nop 0
    buffer_load_dwordx4 v11, s[16:19], s45 offen offset:0 lds
    v_mfma_f32_16x16x32_bf16 v[88:91], v[72:75], v[44:47], v[88:91]
    ds_read_b64_tr_b16 v[56:57], v33 offset:0
    v_mfma_f32_16x16x32_bf16 v[104:107], v[72:75], v[48:51], v[104:107]
    ds_read_b64_tr_b16 v[58:59], v33 offset:512
    s_add_u32 s45, s45, 6144
    buffer_load_dwordx4 v11, s[16:19], s45 offen offset:1024 lds
    v_mfma_f32_16x16x32_bf16 v[116:119], v[14:17], v[44:47], v[116:119]
    v_mfma_f32_16x16x32_bf16 v[124:127], v[44:47], v[44:47], v[124:127]
    s_add_u32 s45, s45, 6144
    buffer_load_dwordx4 v11, s[16:19], s45 offen offset:2048 lds
    v_mfma_f32_16x16x32_bf16 v[120:123], v[14:17], v[48:51], v[120:123]
    v_mfma_f32_16x16x32_bf16 v[128:131], v[48:51], v[48:51], v[128:131]
    s_add_u32 s45, s45, 6144
    buffer_load_dwordx4 v11, s[16:19], s45 offen offset:3072 lds
    v_mfma_f32_16x16x32_bf16 v[208:211], v[68:71], v[14:17], v[208:211]
    v_mfma_f32_16x16x32_bf16 v[212:215], v[72:75], v[14:17], v[212:215]
    s_waitcnt lgkmcnt(0)
    v_mfma_f32_16x16x32_bf16 v[84:87], v[52:55], v[36:39], v[84:87]
    ds_read_b128 v[44:47], v31 offset:0
    ds_read_b128 v[48:51], v31 offset:2048
    v_mfma_f32_16x16x32_bf16 v[100:103], v[52:55], v[40:43], v[100:103]
    ds_read_b64_tr_b16 v[68:69], v32 offset:8192
    ds_read_b64_tr_b16 v[70:71], v32 offset:8704
    v_mfma_f32_16x16x32_bf16 v[88:91], v[56:59], v[36:39], v[88:91]
    ds_read_b64_tr_b16 v[72:73], v33 offset:8192
    v_mfma_f32_16x16x32_bf16 v[104:107], v[56:59], v[40:43], v[104:107]
    ds_read_b64_tr_b16 v[74:75], v33 offset:8704
    v_mfma_f32_16x16x32_bf16 v[116:119], v[14:17], v[36:39], v[116:119]
    v_mfma_f32_16x16x32_bf16 v[124:127], v[36:39], v[36:39], v[124:127]
    v_mfma_f32_16x16x32_bf16 v[120:123], v[14:17], v[40:43], v[120:123]
    v_mfma_f32_16x16x32_bf16 v[128:131], v[40:43], v[40:43], v[128:131]
    v_mfma_f32_16x16x32_bf16 v[208:211], v[52:55], v[14:17], v[208:211]
    v_mfma_f32_16x16x32_bf16 v[212:215], v[56:59], v[14:17], v[212:215]
    s_waitcnt vmcnt(11) lgkmcnt(0)
    s_barrier
    v_add_u32 v30, 0xfffe0000, v30
    v_add_u32 v31, 0xfffe0000, v31
    v_add_u32 v32, 0xfffe0000, v32
    v_add_u32 v33, 0xfffe0000, v33
    v_mfma_f32_16x16x32_bf16 v[84:87], v[68:71], v[44:47], v[84:87]
    ds_read_b128 v[36:39], v30 offset:0
    ds_read_b128 v[40:43], v30 offset:2048
    v_mfma_f32_16x16x32_bf16 v[100:103], v[68:71], v[48:51], v[100:103]
    ds_read_b64_tr_b16 v[52:53], v32 offset:0
    ds_read_b64_tr_b16 v[54:55], v32 offset:512
    s_mul_i32 s45, s3, 21504
    s_lshl_b32 s41, s7, 7
    s_add_u32 s45, s45, s41
    s_mul_i32 s41, s3, 3072
    s_add_u32 m0, s41, 131072
    s_add_u32 s45, s45, 229376
    buffer_load_dwordx4 v11, s[16:19], s45 offen offset:0 lds
    v_mfma_f32_16x16x32_bf16 v[88:91], v[72:75], v[44:47], v[88:91]
    ds_read_b64_tr_b16 v[56:57], v33 offset:0
    v_mfma_f32_16x16x32_bf16 v[104:107], v[72:75], v[48:51], v[104:107]
    ds_read_b64_tr_b16 v[58:59], v33 offset:512
    s_add_u32 s45, s45, 6144
    buffer_load_dwordx4 v11, s[16:19], s45 offen offset:1024 lds
    v_mfma_f32_16x16x32_bf16 v[116:119], v[14:17], v[44:47], v[116:119]
    v_mfma_f32_16x16x32_bf16 v[124:127], v[44:47], v[44:47], v[124:127]
    s_add_u32 s45, s45, 6144
    buffer_load_dwordx4 v11, s[16:19], s45 offen offset:2048 lds
    v_mfma_f32_16x16x32_bf16 v[120:123], v[14:17], v[48:51], v[120:123]
    v_mfma_f32_16x16x32_bf16 v[128:131], v[48:51], v[48:51], v[128:131]
    v_mfma_f32_16x16x32_bf16 v[208:211], v[68:71], v[14:17], v[208:211]
    v_mfma_f32_16x16x32_bf16 v[212:215], v[72:75], v[14:17], v[212:215]
    s_waitcnt lgkmcnt(0)
    v_mfma_f32_16x16x32_bf16 v[84:87], v[52:55], v[36:39], v[84:87]
    ds_read_b128 v[44:47], v31 offset:0
    ds_read_b128 v[48:51], v31 offset:2048
    v_mfma_f32_16x16x32_bf16 v[100:103], v[52:55], v[40:43], v[100:103]
    ds_read_b64_tr_b16 v[68:69], v32 offset:8192
    ds_read_b64_tr_b16 v[70:71], v32 offset:8704
    v_mfma_f32_16x16x32_bf16 v[88:91], v[56:59], v[36:39], v[88:91]
    ds_read_b64_tr_b16 v[72:73], v33 offset:8192
    v_mfma_f32_16x16x32_bf16 v[104:107], v[56:59], v[40:43], v[104:107]
    ds_read_b64_tr_b16 v[74:75], v33 offset:8704
    v_mfma_f32_16x16x32_bf16 v[116:119], v[14:17], v[36:39], v[116:119]
    v_mfma_f32_16x16x32_bf16 v[124:127], v[36:39], v[36:39], v[124:127]
    v_mfma_f32_16x16x32_bf16 v[120:123], v[14:17], v[40:43], v[120:123]
    v_mfma_f32_16x16x32_bf16 v[128:131], v[40:43], v[40:43], v[128:131]
    v_mfma_f32_16x16x32_bf16 v[208:211], v[52:55], v[14:17], v[208:211]
    v_mfma_f32_16x16x32_bf16 v[212:215], v[56:59], v[14:17], v[212:215]
    s_waitcnt vmcnt(7) lgkmcnt(0)
    s_barrier
    v_mfma_f32_16x16x32_bf16 v[84:87], v[68:71], v[44:47], v[84:87]
    ds_read_b128 v[36:39], v30 offset:32768
    ds_read_b128 v[40:43], v30 offset:34816
    v_mfma_f32_16x16x32_bf16 v[100:103], v[68:71], v[48:51], v[100:103]
    ds_read_b64_tr_b16 v[52:53], v32 offset:32768
    ds_read_b64_tr_b16 v[54:55], v32 offset:33280
    s_mul_i32 s52, s50, 229376
    s_add_u32 s52, s52, s51
    s_add_u32 s50, s50, 1
    s_cmp_eq_u32 s50, 7
    s_cselect_b32 s50, 0, s50
    s_add_u32 m0, s53, 0
    s_nop 0
    buffer_load_dwordx4 v10, s[20:23], s52 offen offset:0 lds
    v_mfma_f32_16x16x32_bf16 v[88:91], v[72:75], v[44:47], v[88:91]
    ds_read_b64_tr_b16 v[56:57], v33 offset:32768
    v_mfma_f32_16x16x32_bf16 v[104:107], v[72:75], v[48:51], v[104:107]
    ds_read_b64_tr_b16 v[58:59], v33 offset:33280
    s_add_u32 s52, s52, 27648
    buffer_load_dwordx4 v10, s[20:23], s52 offen offset:1024 lds
    v_mfma_f32_16x16x32_bf16 v[116:119], v[14:17], v[44:47], v[116:119]
    v_mfma_f32_16x16x32_bf16 v[124:127], v[44:47], v[44:47], v[124:127]
    s_add_u32 s52, s52, 27648
    buffer_load_dwordx4 v10, s[20:23], s52 offen offset:2048 lds
    v_mfma_f32_16x16x32_bf16 v[120:123], v[14:17], v[48:51], v[120:123]
    v_mfma_f32_16x16x32_bf16 v[128:131], v[48:51], v[48:51], v[128:131]
    s_add_u32 s52, s52, 27648
    buffer_load_dwordx4 v10, s[20:23], s52 offen offset:3072 lds
    v_mfma_f32_16x16x32_bf16 v[208:211], v[68:71], v[14:17], v[208:211]
    v_mfma_f32_16x16x32_bf16 v[212:215], v[72:75], v[14:17], v[212:215]
    s_waitcnt lgkmcnt(0)
    v_mfma_f32_16x16x32_bf16 v[84:87], v[52:55], v[36:39], v[84:87]
    ds_read_b128 v[44:47], v31 offset:32768
    ds_read_b128 v[48:51], v31 offset:34816
    v_mfma_f32_16x16x32_bf16 v[100:103], v[52:55], v[40:43], v[100:103]
    ds_read_b64_tr_b16 v[68:69], v32 offset:40960
    ds_read_b64_tr_b16 v[70:71], v32 offset:41472
    v_mfma_f32_16x16x32_bf16 v[88:91], v[56:59], v[36:39], v[88:91]
    ds_read_b64_tr_b16 v[72:73], v33 offset:40960
    v_mfma_f32_16x16x32_bf16 v[104:107], v[56:59], v[40:43], v[104:107]
    ds_read_b64_tr_b16 v[74:75], v33 offset:41472
    v_mfma_f32_16x16x32_bf16 v[116:119], v[14:17], v[36:39], v[116:119]
    v_mfma_f32_16x16x32_bf16 v[124:127], v[36:39], v[36:39], v[124:127]
    v_mfma_f32_16x16x32_bf16 v[120:123], v[14:17], v[40:43], v[120:123]
    v_mfma_f32_16x16x32_bf16 v[128:131], v[40:43], v[40:43], v[128:131]
    v_mfma_f32_16x16x32_bf16 v[208:211], v[52:55], v[14:17], v[208:211]
    v_mfma_f32_16x16x32_bf16 v[212:215], v[56:59], v[14:17], v[212:215]
    s_waitcnt lgkmcnt(0)
    v_mfma_f32_16x16x32_bf16 v[84:87], v[68:71], v[44:47], v[84:87]
    ds_read_b64_tr_b16 v[144:145], v13 offset:0
    ds_read_b64_tr_b16 v[146:147], v13 offset:1024
    v_mfma_f32_16x16x32_bf16 v[100:103], v[68:71], v[48:51], v[100:103]
    ds_read_b64_tr_b16 v[148:149], v13 offset:8192
    ds_read_b64_tr_b16 v[150:151], v13 offset:9216
    v_mfma_f32_16x16x32_bf16 v[88:91], v[72:75], v[44:47], v[88:91]
    ds_read_b64_tr_b16 v[152:153], v13 offset:16384
    v_mfma_f32_16x16x32_bf16 v[104:107], v[72:75], v[48:51], v[104:107]
    ds_read_b64_tr_b16 v[154:155], v13 offset:17408
    v_mfma_f32_16x16x32_bf16 v[116:119], v[14:17], v[44:47], v[116:119]
    ds_read_b64_tr_b16 v[156:157], v13 offset:24576
    v_mfma_f32_16x16x32_bf16 v[124:127], v[44:47], v[44:47], v[124:127]
    ds_read_b64_tr_b16 v[158:159], v13 offset:25600
    v_mfma_f32_16x16x32_bf16 v[120:123], v[14:17], v[48:51], v[120:123]
    v_mfma_f32_16x16x32_bf16 v[128:131], v[48:51], v[48:51], v[128:131]
    v_mfma_f32_16x16x32_bf16 v[208:211], v[68:71], v[14:17], v[208:211]
    v_mfma_f32_16x16x32_bf16 v[212:215], v[72:75], v[14:17], v[212:215]
    v_mov_b32 v26, 0x3727c5ac
    v_mov_b32 v27, 1.0
    v_mov_b32 v28, 0
    v_mov_b32 v29, 0
    s_mov_b32 exec_lo, 0x00100001
    s_mov_b32 exec_hi, 0x10000100
    v_mov_b32 v28, v124
    v_mov_b32 v29, v128
    s_lshl_b64 exec, exec, 1
    v_mov_b32 v28, v125
    v_mov_b32 v29, v129
    s_lshl_b64 exec, exec, 1
    v_mov_b32 v28, v126
    v_mov_b32 v29, v130
    s_lshl_b64 exec, exec, 1
    v_mov_b32 v28, v127
    v_mov_b32 v29, v131
    s_mov_b64 exec, -1
    v_mfma_f32_16x16x4_f32 v[124:127], v27, v28, 0
    v_mfma_f32_16x16x4_f32 v[128:131], v27, v29, 0
    s_and_b32 s36, s3, 3
    s_lshl2_add_u32 s36, s4, s36
    s_lshl_b32 s36, s36, 15
    s_lshl1_add_u32 s37, s5, s62
    s_lshl_b32 s37, s37, 10
    s_add_u32 s36, s36, s37
    s_add_u32 s36, s36, 1048576
    s_add_u32 s37, s36, 16384
    s_lshl3_add_u32 s54, s4, s5
    s_lshl_b32 s54, s54, 7
    s_add_u32 s54, s54, 32768
    s_mov_b32 s60, 0
    s_mov_b32 s61, 0xffff0000
    v_mul_f32 v119, s55, v119
    v_mul_f32 v120, s55, v120
    v_fma_f32 v127, v127, s55, v26
    v_fma_f32 v128, v128, s55, v26
    v_fma_f32 v127, -v119, v119, v127
    v_fma_f32 v128, -v120, v120, v128
    v_max_f32 v127, v127, v26
    v_max_f32 v128, v128, v26
    v_rsq_f32 v127, v127
    v_rsq_f32 v128, v128
    v_mul_f32 v45, s56, v127
    v_mul_f32 v46, s56, v128
    v_pk_fma_f32 v[84:85], v[118:119], v[208:209], v[84:85] op_sel:[1,0,0] op_sel_hi:[1,1,1] neg_lo:[1,0,0] neg_hi:[1,0,0]
    v_pk_mul_f32 v[36:37], v[44:45], v[84:85] op_sel:[1,0] op_sel_hi:[1,1]
    v_pk_fma_f32 v[84:85], v[126:127], v[84:85], s[58:59] op_sel:[1,0,0] op_sel_hi:[1,1,1]
    v_exp_f32 v36, v36 clamp
    v_exp_f32 v37, v37 clamp
    v_max_f32 v84, s58, v84
    v_max_f32 v85, s58, v85
    v_pk_add_f32 v[84:85], v[84:85], v[36:37]
    v_cvt_pk_bf16_f32 v68, v84, v85
    v_pk_fma_f32 v[86:87], v[118:119], v[210:211], v[86:87] op_sel:[1,0,0] op_sel_hi:[1,1,1] neg_lo:[1,0,0] neg_hi:[1,0,0]
    v_pk_mul_f32 v[38:39], v[44:45], v[86:87] op_sel:[1,0] op_sel_hi:[1,1]
    v_pk_fma_f32 v[86:87], v[126:127], v[86:87], s[58:59] op_sel:[1,0,0] op_sel_hi:[1,1,1]
    v_exp_f32 v38, v38 clamp
    v_exp_f32 v39, v39 clamp
    v_max_f32 v86, s58, v86
    v_max_f32 v87, s58, v87
    v_pk_add_f32 v[86:87], v[86:87], v[38:39]
    v_cvt_pk_bf16_f32 v69, v86, v87
    v_pk_fma_f32 v[88:89], v[118:119], v[212:213], v[88:89] op_sel:[1,0,0] op_sel_hi:[1,1,1] neg_lo:[1,0,0] neg_hi:[1,0,0]
    v_pk_mul_f32 v[40:41], v[44:45], v[88:89] op_sel:[1,0] op_sel_hi:[1,1]
    v_pk_fma_f32 v[88:89], v[126:127], v[88:89], s[58:59] op_sel:[1,0,0] op_sel_hi:[1,1,1]
    v_exp_f32 v40, v40 clamp
    v_exp_f32 v41, v41 clamp
    v_max_f32 v88, s58, v88
    v_max_f32 v89, s58, v89
    v_pk_add_f32 v[88:89], v[88:89], v[40:41]
    v_cvt_pk_bf16_f32 v70, v88, v89
    v_pk_fma_f32 v[90:91], v[118:119], v[214:215], v[90:91] op_sel:[1,0,0] op_sel_hi:[1,1,1] neg_lo:[1,0,0] neg_hi:[1,0,0]
    v_pk_mul_f32 v[42:43], v[44:45], v[90:91] op_sel:[1,0] op_sel_hi:[1,1]
    v_pk_fma_f32 v[90:91], v[126:127], v[90:91], s[58:59] op_sel:[1,0,0] op_sel_hi:[1,1,1]
    v_exp_f32 v42, v42 clamp
    v_exp_f32 v43, v43 clamp
    v_max_f32 v90, s58, v90
    v_max_f32 v91, s58, v91
    v_pk_add_f32 v[90:91], v[90:91], v[42:43]
    v_cvt_pk_bf16_f32 v71, v90, v91
    v_cndmask_b32 v70, v70, 0, s[60:61]
    v_cndmask_b32 v71, v71, 0, s[60:61]
    buffer_store_dwordx4 v[68:71], v4, s[32:35], s36 offen sc1
    v_pk_fma_f32 v[100:101], v[120:121], v[208:209], v[100:101] op_sel:[0,0,0] op_sel_hi:[0,1,1] neg_lo:[1,0,0] neg_hi:[1,0,0]
    v_pk_mul_f32 v[36:37], v[46:47], v[100:101] op_sel:[0,0] op_sel_hi:[0,1]
    v_pk_fma_f32 v[100:101], v[128:129], v[100:101], s[58:59] op_sel:[0,0,0] op_sel_hi:[0,1,1]
    v_exp_f32 v36, v36 clamp
    v_exp_f32 v37, v37 clamp
    v_max_f32 v100, s58, v100
    v_max_f32 v101, s58, v101
    v_pk_add_f32 v[100:101], v[100:101], v[36:37]
    v_cvt_pk_bf16_f32 v72, v100, v101
    v_pk_fma_f32 v[102:103], v[120:121], v[210:211], v[102:103] op_sel:[0,0,0] op_sel_hi:[0,1,1] neg_lo:[1,0,0] neg_hi:[1,0,0]
    v_pk_mul_f32 v[38:39], v[46:47], v[102:103] op_sel:[0,0] op_sel_hi:[0,1]
    v_pk_fma_f32 v[102:103], v[128:129], v[102:103], s[58:59] op_sel:[0,0,0] op_sel_hi:[0,1,1]
    v_exp_f32 v38, v38 clamp
    v_exp_f32 v39, v39 clamp
    v_max_f32 v102, s58, v102
    v_max_f32 v103, s58, v103
    v_pk_add_f32 v[102:103], v[102:103], v[38:39]
    v_cvt_pk_bf16_f32 v73, v102, v103
    v_pk_fma_f32 v[104:105], v[120:121], v[212:213], v[104:105] op_sel:[0,0,0] op_sel_hi:[0,1,1] neg_lo:[1,0,0] neg_hi:[1,0,0]
    v_pk_mul_f32 v[40:41], v[46:47], v[104:105] op_sel:[0,0] op_sel_hi:[0,1]
    v_pk_fma_f32 v[104:105], v[128:129], v[104:105], s[58:59] op_sel:[0,0,0] op_sel_hi:[0,1,1]
    v_exp_f32 v40, v40 clamp
    v_exp_f32 v41, v41 clamp
    v_max_f32 v104, s58, v104
    v_max_f32 v105, s58, v105
    v_pk_add_f32 v[104:105], v[104:105], v[40:41]
    v_cvt_pk_bf16_f32 v74, v104, v105
    v_pk_fma_f32 v[106:107], v[120:121], v[214:215], v[106:107] op_sel:[0,0,0] op_sel_hi:[0,1,1] neg_lo:[1,0,0] neg_hi:[1,0,0]
    v_pk_mul_f32 v[42:43], v[46:47], v[106:107] op_sel:[0,0] op_sel_hi:[0,1]
    v_pk_fma_f32 v[106:107], v[128:129], v[106:107], s[58:59] op_sel:[0,0,0] op_sel_hi:[0,1,1]
    v_exp_f32 v42, v42 clamp
    v_exp_f32 v43, v43 clamp
    v_max_f32 v106, s58, v106
    v_max_f32 v107, s58, v107
    v_pk_add_f32 v[106:107], v[106:107], v[42:43]
    v_cvt_pk_bf16_f32 v75, v106, v107
    v_cndmask_b32 v74, v74, 0, s[60:61]
    v_cndmask_b32 v75, v75, 0, s[60:61]
    buffer_store_dwordx4 v[72:75], v4, s[32:35], s37 offen sc1
    s_waitcnt vmcnt(0) lgkmcnt(0)
    s_barrier
    s_cmp_eq_u32 s3, 0
    s_cbranch_scc0 .Lfl_36
    s_mov_b64 exec, 0xff
    buffer_store_dwordx4 v[4:7], v4, s[32:35], s54 offen offset:0 sc1
    s_mov_b64 exec, -1
.Lfl_36:
    ds_read_b64_tr_b16 v[160:161], v12 offset:0
    ds_read_b64_tr_b16 v[162:163], v12 offset:1024
    ds_read_b64_tr_b16 v[164:165], v12 offset:8192
    ds_read_b64_tr_b16 v[166:167], v12 offset:9216
    ds_read_b64_tr_b16 v[168:169], v12 offset:16384
    ds_read_b64_tr_b16 v[170:171], v12 offset:17408
    ds_read_b64_tr_b16 v[172:173], v12 offset:24576
    ds_read_b64_tr_b16 v[174:175], v12 offset:25600
    ds_read_b64_tr_b16 v[136:137], v132 offset:0
    ds_read_b64_tr_b16 v[138:139], v134 offset:0
    ds_read_b64_tr_b16 v[140:141], v133 offset:3584
    ds_read_b64_tr_b16 v[142:143], v135 offset:3584
    ds_read_b64_tr_b16 v[52:53], v132 offset:7168
    ds_read_b64_tr_b16 v[54:55], v134 offset:7168
    ds_read_b64_tr_b16 v[56:57], v133 offset:10752
    ds_read_b64_tr_b16 v[58:59], v135 offset:10752
    ds_read_b64_tr_b16 v[60:61], v132 offset:14336
    ds_read_b64_tr_b16 v[62:63], v134 offset:14336
    ds_read_b64_tr_b16 v[64:65], v133 offset:17920
    ds_read_b64_tr_b16 v[66:67], v135 offset:17920
    ds_read_b64_tr_b16 v[116:117], v132 offset:21504
    ds_read_b64_tr_b16 v[118:119], v134 offset:21504
    ds_read_b64_tr_b16 v[120:121], v133 offset:25088
    ds_read_b64_tr_b16 v[122:123], v135 offset:25088
    ds_read_b64_tr_b16 v[36:37], v132 offset:28672
    ds_read_b64_tr_b16 v[38:39], v134 offset:28672
    ds_read_b64_tr_b16 v[40:41], v133 offset:32256
    ds_read_b64_tr_b16 v[42:43], v135 offset:32256
    ds_read_b64_tr_b16 v[44:45], v132 offset:35840
    ds_read_b64_tr_b16 v[46:47], v134 offset:35840
    ds_read_b64_tr_b16 v[48:49], v133 offset:39424
    ds_read_b64_tr_b16 v[50:51], v135 offset:39424
    ds_read_b64_tr_b16 v[124:125], v132 offset:43008
    ds_read_b64_tr_b16 v[126:127], v134 offset:43008
    ds_read_b64_tr_b16 v[128:129], v133 offset:46592
    ds_read_b64_tr_b16 v[130:131], v135 offset:46592
    ds_read_b64_tr_b16 v[68:69], v132 offset:50176
    ds_read_b64_tr_b16 v[70:71], v134 offset:50176
    ds_read_b64_tr_b16 v[72:73], v133 offset:53760
    ds_read_b64_tr_b16 v[74:75], v135 offset:53760
    s_mul_i32 s52, s50, 229376
    s_add_u32 s52, s52, s51
    s_add_u32 s50, s50, 1
    s_cmp_eq_u32 s50, 7
    s_cselect_b32 s50, 0, s50
    s_add_u32 m0, s53, 65536
    s_nop 0
    buffer_load_dwordx4 v10, s[20:23], s52 offen offset:0 lds
    s_add_u32 s52, s52, 27648
    buffer_load_dwordx4 v10, s[20:23], s52 offen offset:1024 lds
    s_add_u32 s52, s52, 27648
    buffer_load_dwordx4 v10, s[20:23], s52 offen offset:2048 lds
    s_add_u32 s52, s52, 27648
    buffer_load_dwordx4 v10, s[20:23], s52 offen offset:3072 lds
    s_lshl3_add_u32 s41, s4, s3
    s_lshl_b32 s41, s41, 7
    s_add_u32 s41, s41, 32772
    s_mov_b64 exec, 0x00000001
    buffer_load_dword v0, off, s[32:35], s41 sc1
    s_mov_b64 exec, -1
    s_mul_i32 s52, s50, 229376
    s_add_u32 s52, s52, s51
    s_add_u32 s50, s50, 1
    s_cmp_eq_u32 s50, 7
    s_cselect_b32 s50, 0, s50
    s_add_u32 m0, s53, 32768
    s_nop 0
    buffer_load_dwordx4 v10, s[20:23], s52 offen offset:0 lds
    s_add_u32 s52, s52, 27648
    buffer_load_dwordx4 v10, s[20:23], s52 offen offset:1024 lds
    s_add_u32 s52, s52, 27648
    buffer_load_dwordx4 v10, s[20:23], s52 offen offset:2048 lds
    s_add_u32 s52, s52, 27648
    buffer_load_dwordx4 v10, s[20:23], s52 offen offset:3072 lds
    s_lshl1_add_u32 s46, s4, s40
    s_lshl_b32 s46, s46, 2
    s_lshl3_add_u32 s38, s46, s3
    s_lshl_b32 s38, s38, 11
    s_add_u32 s38, s38, 1048576
    s_waitcnt vmcnt(4)
    s_mov_b64 exec, 0x00000001
.Lpw_37:
    v_cmp_ne_u32 vcc, v0, v5
    s_and_b64 exec, exec, vcc
    s_cbranch_scc0 .Lpd_38
    buffer_load_dword v0, off, s[32:35], s41 sc1
    s_sub_u32 s48, s48, 1
    s_waitcnt vmcnt(0)
    s_cbranch_scc0 .Lpw_37
    s_mov_b32 s48, 0
.Lpd_38:
    s_mov_b64 exec, -1
    buffer_load_dwordx4 v[224:227], v4, s[32:35], s38 offen offset:0 sc1
    buffer_load_dwordx4 v[228:231], v4, s[32:35], s38 offen offset:1024 sc1
    s_add_u32 s38, s38, 16384
    buffer_load_dwordx4 v[232:235], v4, s[32:35], s38 offen offset:0 sc1
    buffer_load_dwordx4 v[236:239], v4, s[32:35], s38 offen offset:1024 sc1
    s_add_u32 s38, s38, 16384
    buffer_load_dwordx4 v[240:243], v4, s[32:35], s38 offen offset:0 sc1
    buffer_load_dwordx4 v[244:247], v4, s[32:35], s38 offen offset:1024 sc1
    s_add_u32 s38, s38, 16384
    buffer_load_dwordx4 v[248:251], v4, s[32:35], s38 offen offset:0 sc1
    buffer_load_dwordx4 v[252:255], v4, s[32:35], s38 offen offset:1024 sc1
    s_waitcnt vmcnt(8)
    s_barrier
    ds_read_b64_tr_b16 v[176:177], v13 offset:0
    ds_read_b64_tr_b16 v[178:179], v13 offset:1024
    ds_read_b64_tr_b16 v[180:181], v13 offset:8192
    ds_read_b64_tr_b16 v[182:183], v13 offset:9216
    ds_read_b64_tr_b16 v[184:185], v13 offset:16384
    ds_read_b64_tr_b16 v[186:187], v13 offset:17408
    ds_read_b64_tr_b16 v[188:189], v13 offset:24576
    ds_read_b64_tr_b16 v[190:191], v13 offset:25600
    ds_read_b64_tr_b16 v[192:193], v12 offset:32768
    ds_read_b64_tr_b16 v[194:195], v12 offset:33792
    ds_read_b64_tr_b16 v[196:197], v12 offset:40960
    ds_read_b64_tr_b16 v[198:199], v12 offset:41984
    ds_read_b64_tr_b16 v[200:201], v12 offset:49152
    ds_read_b64_tr_b16 v[202:203], v12 offset:50176
    ds_read_b64_tr_b16 v[204:205], v12 offset:57344
    ds_read_b64_tr_b16 v[206:207], v12 offset:58368
.Ljoin:
    s_lshl1_add_u32 s42, s62, s46
    s_and_b32 s43, s3, 3
    s_lshl2_add_u32 s43, s7, s43
    s_mul_i32 s44, s42, 14336
    s_lshl_b32 s36, s43, 5
    s_add_u32 s36, s36, s44
    s_add_u32 s37, s36, 14336
    s_mov_b32 s59, s36
    v_mul_u32_u24 v6, 896, v2
    v_lshl_add_u32 v6, v3, 3, v6
    buffer_load_dwordx2 v[30:31], v6, s[8:11], s36 offen
    buffer_load_dwordx2 v[32:33], v6, s[8:11], s37 offen
    v_mfma_f32_16x16x32_bf16 v[18:21], v[144:147], v[14:17], 0
    v_mfma_f32_16x16x32_bf16 v[22:25], v[148:151], v[14:17], 0
    v_mfma_f32_16x16x32_bf16 v[18:21], v[152:155], v[14:17], v[18:21]
    v_mfma_f32_16x16x32_bf16 v[22:25], v[156:159], v[14:17], v[22:25]
    v_mfma_f32_16x16x32_bf16 v[18:21], v[160:163], v[14:17], v[18:21]
    v_mfma_f32_16x16x32_bf16 v[22:25], v[164:167], v[14:17], v[22:25]
    v_mfma_f32_16x16x32_bf16 v[18:21], v[168:171], v[14:17], v[18:21]
    v_mfma_f32_16x16x32_bf16 v[22:25], v[172:175], v[14:17], v[22:25]
    s_waitcnt lgkmcnt(0)
    v_mfma_f32_16x16x32_bf16 v[18:21], v[176:179], v[14:17], v[18:21]
    v_mfma_f32_16x16x32_bf16 v[22:25], v[180:183], v[14:17], v[22:25]
    v_mfma_f32_16x16x32_bf16 v[18:21], v[184:187], v[14:17], v[18:21]
    v_mfma_f32_16x16x32_bf16 v[22:25], v[188:191], v[14:17], v[22:25]
    v_mfma_f32_16x16x32_bf16 v[18:21], v[192:195], v[14:17], v[18:21]
    v_mfma_f32_16x16x32_bf16 v[22:25], v[196:199], v[14:17], v[22:25]
    v_mfma_f32_16x16x32_bf16 v[18:21], v[200:203], v[14:17], v[18:21]
    v_mfma_f32_16x16x32_bf16 v[22:25], v[204:207], v[14:17], v[22:25]
    v_mov_b32 v132, 0
    v_mov_b32 v133, 0
    v_mov_b32 v134, 0
    v_mov_b32 v135, s58
    s_lshl_b32 s36, s3, 11
    s_add_u32 s36, s36, 32768
    v_add_u32 v34, s36, v4
    s_lshl_b32 s36, s62, 15
    s_add_u32 s36, s36, 32768
    v_add_u32 v35, s36, v4
    s_lshl3_add_u32 s41, s4, s3
    s_lshl_b32 s41, s41, 11
    s_lshl_b32 s36, s3, 15
    s_add_u32 s54, s54, s36
    v_and_b32 v8, 128, v4
    v_mul_u32_u24 v8, 127, v8
    v_add_u32 v8, v8, v4
    s_add_u32 s41, s41, 262148
    v_lshlrev_b32 v9, 3, v4
    s_cmp_ge_u32 s49, 8
    s_cbranch_scc1 .Lf_39
    s_waitcnt vmcnt(2)
    s_barrier
    s_mov_b64 exec, 0xffff
    buffer_store_dwordx4 v[4:7], v8, s[32:35], s54 offen sc1
    s_mov_b64 exec, -1
    s_branch .Lf_39x
.Lf_39:
    s_barrier
    s_cmp_ge_u32 s49, 14
    s_cbranch_scc1 .Lhelp
.Lf_39x:
    s_mul_i32 s52, s50, 229376
    s_add_u32 s52, s52, s51
    s_add_u32 s50, s50, 1
    s_cmp_eq_u32 s50, 7
    s_cselect_b32 s50, 0, s50
    s_add_u32 m0, s53, 0
    s_nop 0
    buffer_load_dwordx4 v10, s[20:23], s52 offen offset:0 lds
    s_add_u32 s52, s52, 27648
    buffer_load_dwordx4 v10, s[20:23], s52 offen offset:1024 lds
    s_add_u32 s52, s52, 27648
    buffer_load_dwordx4 v10, s[20:23], s52 offen offset:2048 lds
    s_add_u32 s52, s52, 27648
    buffer_load_dwordx4 v10, s[20:23], s52 offen offset:3072 lds
    s_mul_i32 s52, s50, 229376
    s_add_u32 s52, s52, s51
    s_add_u32 s50, s50, 1
    s_cmp_eq_u32 s50, 7
    s_cselect_b32 s50, 0, s50
    s_add_u32 m0, s53, 98304
    s_nop 0
    buffer_load_dwordx4 v10, s[20:23], s52 offen offset:0 lds
    s_add_u32 s52, s52, 27648
    buffer_load_dwordx4 v10, s[20:23], s52 offen offset:1024 lds
    s_add_u32 s52, s52, 27648
    buffer_load_dwordx4 v10, s[20:23], s52 offen offset:2048 lds
    s_add_u32 s52, s52, 27648
    buffer_load_dwordx4 v10, s[20:23], s52 offen offset:3072 lds
    s_mul_i32 s52, s50, 229376
    s_add_u32 s52, s52, s51
    s_add_u32 s50, s50, 1
    s_cmp_eq_u32 s50, 7
    s_cselect_b32 s50, 0, s50
    s_add_u32 m0, s53, 131072
    s_nop 0
    buffer_load_dwordx4 v10, s[20:23], s52 offen offset:0 lds
    s_add_u32 s52, s52, 27648
    buffer_load_dwordx4 v10, s[20:23], s52 offen offset:1024 lds
    s_add_u32 s52, s52, 27648
    buffer_load_dwordx4 v10, s[20:23], s52 offen offset:2048 lds
    s_add_u32 s52, s52, 27648
    buffer_load_dwordx4 v10, s[20:23], s52 offen offset:3072 lds
    s_mov_b64 exec, 0x0000ffff
    buffer_load_dword v0, v9, s[32:35], s41 offen sc1
    s_mov_b64 exec, -1
    s_lshl_b32 s36, s3, 13
    s_add_u32 s36, s36, 131072
    s_add_u32 s37, s36, 4096
    s_waitcnt vmcnt(0)
    s_mov_b64 exec, 0x0000ffff
.Lpw_40:
    v_cmp_ne_u32 vcc, v0, v5
    s_and_b64 exec, exec, vcc
    s_cbranch_scc0 .Lpd_41
    buffer_load_dword v0, v9, s[32:35], s41 offen sc1
    s_sub_u32 s48, s48, 1
    s_waitcnt vmcnt(0)
    s_cbranch_scc0 .Lpw_40
    s_mov_b32 s48, 0
.Lpd_41:
    s_mov_b64 exec, -1
    buffer_load_dwordx4 v[84:87], v4, s[32:35], s36 offen offset:0 sc1
    buffer_load_dwordx4 v[88:91], v4, s[32:35], s36 offen offset:1024 sc1
    buffer_load_dwordx4 v[92:95], v4, s[32:35], s36 offen offset:2048 sc1
    buffer_load_dwordx4 v[96:99], v4, s[32:35], s36 offen offset:3072 sc1
    buffer_load_dwordx4 v[100:103], v4, s[32:35], s37 offen offset:0 sc1
    buffer_load_dwordx4 v[104:107], v4, s[32:35], s37 offen offset:1024 sc1
    buffer_load_dwordx4 v[108:111], v4, s[32:35], s37 offen offset:2048 sc1
    buffer_load_dwordx4 v[112:115], v4, s[32:35], s37 offen offset:3072 sc1
    v_lshlrev_b32 v76, 16, v30
    v_and_b32 v77, 0xffff0000, v30
    v_lshlrev_b32 v78, 16, v31
    v_and_b32 v79, 0xffff0000, v31
    v_lshlrev_b32 v80, 16, v32
    v_and_b32 v81, 0xffff0000, v32
    v_lshlrev_b32 v82, 16, v33
    v_and_b32 v83, 0xffff0000, v33
    s_lshl_b32 s36, s43, 9
    s_add_u32 s44, s44, s36
    s_add_u32 s44, s44, 4194304
    s_lshl_b32 s42, s42, 5
    s_add_u32 s42, s42, s43
    s_lshl_b32 s42, s42, 7
    s_add_u32 s42, s42, 3145728
    v_lshrrev_b32 v6, 5, v1
    v_mul_u32_u24 v8, 13824, v6
    v_add_u32 v8, v8, v4
    v_mul_u32_u24 v9, 3968, v6
    v_lshl_add_u32 v9, v1, 2, v9
    s_waitcnt vmcnt(6)
    v_cvt_pk_bf16_f32 v84, v84, v85
    v_cvt_pk_bf16_f32 v85, v86, v87
    v_cvt_pk_bf16_f32 v86, v88, v89
    v_cvt_pk_bf16_f32 v87, v90, v91
    s_waitcnt vmcnt(4)
    v_cvt_pk_bf16_f32 v92, v92, v93
    v_cvt_pk_bf16_f32 v93, v94, v95
    v_cvt_pk_bf16_f32 v94, v96, v97
    v_cvt_pk_bf16_f32 v95, v98, v99
    s_nop 1
    v_mfma_f32_16x16x32_bf16 v[96:99], v[92:95], v[224:227], v[132:135]
    v_mfma_f32_16x16x32_bf16 v[88:91], v[84:87], v[224:227], 0
    v_mfma_f32_16x16x32_bf16 v[212:215], v[92:95], v[232:235], v[132:135]
    v_mfma_f32_16x16x32_bf16 v[208:211], v[84:87], v[232:235], 0
    v_mfma_f32_16x16x32_bf16 v[220:223], v[92:95], v[240:243], v[132:135]
    v_mfma_f32_16x16x32_bf16 v[216:219], v[84:87], v[240:243], 0
    v_mfma_f32_16x16x32_bf16 v[30:33], v[92:95], v[248:251], v[132:135]
    v_mfma_f32_16x16x32_bf16 v[26:29], v[84:87], v[248:251], 0
    s_nop 0
    v_rcp_f32 v99, v99
    s_nop 0
    v_rcp_f32 v215, v215
    s_nop 0
    v_rcp_f32 v223, v223
    s_nop 0
    v_rcp_f32 v33, v33
    v_pk_mul_f32 v[96:97], v[98:99], v[96:97] op_sel:[1,0] op_sel_hi:[1,1]
    v_pk_mul_f32 v[88:89], v[98:99], v[88:89] op_sel:[1,0] op_sel_hi:[1,1]
    v_pk_mul_f32 v[90:91], v[98:99], v[90:91] op_sel:[1,0] op_sel_hi:[1,1]
    v_mul_f32 v98, v98, v99
    v_cvt_pk_bf16_f32 v226, v96, v97
    v_cvt_pk_bf16_f32 v224, v88, v89
    v_cvt_pk_bf16_f32 v225, v90, v91
    v_cvt_pk_bf16_f32 v227, v98, 0
    ds_write_b128 v34, v[224:227] offset:0
    v_pk_mul_f32 v[212:213], v[214:215], v[212:213] op_sel:[1,0] op_sel_hi:[1,1]
    v_pk_mul_f32 v[208:209], v[214:215], v[208:209] op_sel:[1,0] op_sel_hi:[1,1]
    v_pk_mul_f32 v[210:211], v[214:215], v[210:211] op_sel:[1,0] op_sel_hi:[1,1]
    v_mul_f32 v214, v214, v215
    v_cvt_pk_bf16_f32 v234, v212, v213
    v_cvt_pk_bf16_f32 v232, v208, v209
    v_cvt_pk_bf16_f32 v233, v210, v211
    v_cvt_pk_bf16_f32 v235, v214, 0
    ds_write_b128 v34, v[232:235] offset:16384
    v_pk_mul_f32 v[220:221], v[222:223], v[220:221] op_sel:[1,0] op_sel_hi:[1,1]
    v_pk_mul_f32 v[216:217], v[222:223], v[216:217] op_sel:[1,0] op_sel_hi:[1,1]
    v_pk_mul_f32 v[218:219], v[222:223], v[218:219] op_sel:[1,0] op_sel_hi:[1,1]
    v_mul_f32 v222, v222, v223
    v_cvt_pk_bf16_f32 v242, v220, v221
    v_cvt_pk_bf16_f32 v240, v216, v217
    v_cvt_pk_bf16_f32 v241, v218, v219
    v_cvt_pk_bf16_f32 v243, v222, 0
    ds_write_b128 v34, v[240:243] offset:32768
    v_pk_mul_f32 v[30:31], v[32:33], v[30:31] op_sel:[1,0] op_sel_hi:[1,1]
    v_pk_mul_f32 v[26:27], v[32:33], v[26:27] op_sel:[1,0] op_sel_hi:[1,1]
    v_pk_mul_f32 v[28:29], v[32:33], v[28:29] op_sel:[1,0] op_sel_hi:[1,1]
    v_mul_f32 v32, v32, v33
    v_cvt_pk_bf16_f32 v250, v30, v31
    v_cvt_pk_bf16_f32 v248, v26, v27
    v_cvt_pk_bf16_f32 v249, v28, v29
    v_cvt_pk_bf16_f32 v251, v32, 0
    ds_write_b128 v34, v[248:251] offset:49152
    s_waitcnt vmcnt(2)
    v_cvt_pk_bf16_f32 v100, v100, v101
    v_cvt_pk_bf16_f32 v101, v102, v103
    v_cvt_pk_bf16_f32 v102, v104, v105
    v_cvt_pk_bf16_f32 v103, v106, v107
    s_waitcnt vmcnt(0)
    v_cvt_pk_bf16_f32 v108, v108, v109
    v_cvt_pk_bf16_f32 v109, v110, v111
    v_cvt_pk_bf16_f32 v110, v112, v113
    v_cvt_pk_bf16_f32 v111, v114, v115
    s_nop 1
    v_mfma_f32_16x16x32_bf16 v[96:99], v[108:111], v[228:231], v[132:135]
    v_mfma_f32_16x16x32_bf16 v[88:91], v[100:103], v[228:231], 0
    v_mfma_f32_16x16x32_bf16 v[212:215], v[108:111], v[236:239], v[132:135]
    v_mfma_f32_16x16x32_bf16 v[208:211], v[100:103], v[236:239], 0
    v_mfma_f32_16x16x32_bf16 v[220:223], v[108:111], v[244:247], v[132:135]
    v_mfma_f32_16x16x32_bf16 v[216:219], v[100:103], v[244:247], 0
    v_mfma_f32_16x16x32_bf16 v[30:33], v[108:111], v[252:255], v[132:135]
    v_mfma_f32_16x16x32_bf16 v[26:29], v[100:103], v[252:255], 0
    s_nop 0
    v_rcp_f32 v99, v99
    s_nop 0
    v_rcp_f32 v215, v215
    s_nop 0
    v_rcp_f32 v223, v223
    s_nop 0
    v_rcp_f32 v33, v33
    v_pk_mul_f32 v[96:97], v[98:99], v[96:97] op_sel:[1,0] op_sel_hi:[1,1]
    v_pk_mul_f32 v[88:89], v[98:99], v[88:89] op_sel:[1,0] op_sel_hi:[1,1]
    v_pk_mul_f32 v[90:91], v[98:99], v[90:91] op_sel:[1,0] op_sel_hi:[1,1]
    v_mul_f32 v98, v98, v99
    v_cvt_pk_bf16_f32 v230, v96, v97
    v_cvt_pk_bf16_f32 v228, v88, v89
    v_cvt_pk_bf16_f32 v229, v90, v91
    v_cvt_pk_bf16_f32 v231, v98, 0
    ds_write_b128 v34, v[228:231] offset:1024
    v_pk_mul_f32 v[212:213], v[214:215], v[212:213] op_sel:[1,0] op_sel_hi:[1,1]
    v_pk_mul_f32 v[208:209], v[214:215], v[208:209] op_sel:[1,0] op_sel_hi:[1,1]
    v_pk_mul_f32 v[210:211], v[214:215], v[210:211] op_sel:[1,0] op_sel_hi:[1,1]
    v_mul_f32 v214, v214, v215
    v_cvt_pk_bf16_f32 v238, v212, v213
    v_cvt_pk_bf16_f32 v236, v208, v209
    v_cvt_pk_bf16_f32 v237, v210, v211
    v_cvt_pk_bf16_f32 v239, v214, 0
    ds_write_b128 v34, v[236:239] offset:17408
    v_pk_mul_f32 v[220:221], v[222:223], v[220:221] op_sel:[1,0] op_sel_hi:[1,1]
    v_pk_mul_f32 v[216:217], v[222:223], v[216:217] op_sel:[1,0] op_sel_hi:[1,1]
    v_pk_mul_f32 v[218:219], v[222:223], v[218:219] op_sel:[1,0] op_sel_hi:[1,1]
    v_mul_f32 v222, v222, v223
    v_cvt_pk_bf16_f32 v246, v220, v221
    v_cvt_pk_bf16_f32 v244, v216, v217
    v_cvt_pk_bf16_f32 v245, v218, v219
    v_cvt_pk_bf16_f32 v247, v222, 0
    ds_write_b128 v34, v[244:247] offset:33792
    v_pk_mul_f32 v[30:31], v[32:33], v[30:31] op_sel:[1,0] op_sel_hi:[1,1]
    v_pk_mul_f32 v[26:27], v[32:33], v[26:27] op_sel:[1,0] op_sel_hi:[1,1]
    v_pk_mul_f32 v[28:29], v[32:33], v[28:29] op_sel:[1,0] op_sel_hi:[1,1]
    v_mul_f32 v32, v32, v33
    v_cvt_pk_bf16_f32 v254, v30, v31
    v_cvt_pk_bf16_f32 v252, v26, v27
    v_cvt_pk_bf16_f32 v253, v28, v29
    v_cvt_pk_bf16_f32 v255, v32, 0
    ds_write_b128 v34, v[252:255] offset:50176
    s_waitcnt lgkmcnt(0)
    s_barrier
    ds_read_b128 v[84:87], v35 offset:0
    ds_read_b128 v[88:91], v35 offset:16384
    ds_read_b128 v[92:95], v35 offset:1024
    ds_read_b128 v[96:99], v35 offset:17408
    ds_read_b128 v[100:103], v35 offset:2048
    ds_read_b128 v[104:107], v35 offset:18432
    ds_read_b128 v[108:111], v35 offset:3072
    ds_read_b128 v[112:115], v35 offset:19456
    s_waitcnt lgkmcnt(7)
    v_mfma_f32_16x16x32_bf16 v[76:79], v[136:139], v[84:87], v[76:79]
    ds_read_b128 v[84:87], v35 offset:4096
    s_waitcnt lgkmcnt(7)
    v_mfma_f32_16x16x32_bf16 v[80:83], v[136:139], v[88:91], v[80:83]
    ds_read_b128 v[88:91], v35 offset:20480
    s_waitcnt lgkmcnt(7)
    v_mfma_f32_16x16x32_bf16 v[76:79], v[140:143], v[92:95], v[76:79]
    ds_read_b128 v[92:95], v35 offset:5120
    s_waitcnt lgkmcnt(7)
    v_mfma_f32_16x16x32_bf16 v[80:83], v[140:143], v[96:99], v[80:83]
    ds_read_b128 v[96:99], v35 offset:21504
    s_waitcnt lgkmcnt(7)
    v_mfma_f32_16x16x32_bf16 v[76:79], v[52:55], v[100:103], v[76:79]
    ds_read_b128 v[100:103], v35 offset:6144
    s_waitcnt lgkmcnt(7)
    v_mfma_f32_16x16x32_bf16 v[80:83], v[52:55], v[104:107], v[80:83]
    ds_read_b128 v[104:107], v35 offset:22528
    s_waitcnt lgkmcnt(7)
    v_mfma_f32_16x16x32_bf16 v[76:79], v[56:59], v[108:111], v[76:79]
    ds_read_b128 v[108:111], v35 offset:7168
    s_waitcnt lgkmcnt(7)
    v_mfma_f32_16x16x32_bf16 v[80:83], v[56:59], v[112:115], v[80:83]
    ds_read_b128 v[112:115], v35 offset:23552
    s_waitcnt lgkmcnt(7)
    v_mfma_f32_16x16x32_bf16 v[76:79], v[60:63], v[84:87], v[76:79]
    ds_read_b128 v[84:87], v35 offset:8192
    s_waitcnt lgkmcnt(7)
    v_mfma_f32_16x16x32_bf16 v[80:83], v[60:63], v[88:91], v[80:83]
    ds_read_b128 v[88:91], v35 offset:24576
    s_waitcnt lgkmcnt(7)
    v_mfma_f32_16x16x32_bf16 v[76:79], v[64:67], v[92:95], v[76:79]
    ds_read_b128 v[92:95], v35 offset:9216
    s_waitcnt lgkmcnt(7)
    v_mfma_f32_16x16x32_bf16 v[80:83], v[64:67], v[96:99], v[80:83]
    ds_read_b128 v[96:99], v35 offset:25600
    s_waitcnt lgkmcnt(7)
    v_mfma_f32_16x16x32_bf16 v[76:79], v[116:119], v[100:103], v[76:79]
    ds_read_b128 v[100:103], v35 offset:10240
    s_waitcnt lgkmcnt(7)
    v_mfma_f32_16x16x32_bf16 v[80:83], v[116:119], v[104:107], v[80:83]
    ds_read_b128 v[104:107], v35 offset:26624
    s_waitcnt lgkmcnt(7)
    v_mfma_f32_16x16x32_bf16 v[76:79], v[120:123], v[108:111], v[76:79]
    ds_read_b128 v[108:111], v35 offset:11264
    s_waitcnt lgkmcnt(7)
    v_mfma_f32_16x16x32_bf16 v[80:83], v[120:123], v[112:115], v[80:83]
    ds_read_b128 v[112:115], v35 offset:27648
    s_waitcnt lgkmcnt(7)
    v_mfma_f32_16x16x32_bf16 v[76:79], v[36:39], v[84:87], v[76:79]
    ds_read_b128 v[84:87], v35 offset:12288
    s_waitcnt lgkmcnt(7)
    v_mfma_f32_16x16x32_bf16 v[80:83], v[36:39], v[88:91], v[80:83]
    ds_read_b128 v[88:91], v35 offset:28672
    s_waitcnt lgkmcnt(7)
    v_mfma_f32_16x16x32_bf16 v[76:79], v[40:43], v[92:95], v[76:79]
    ds_read_b128 v[92:95], v35 offset:13312
    s_waitcnt lgkmcnt(7)
    v_mfma_f32_16x16x32_bf16 v[80:83], v[40:43], v[96:99], v[80:83]
    ds_read_b128 v[96:99], v35 offset:29696
    s_waitcnt lgkmcnt(7)
    v_mfma_f32_16x16x32_bf16 v[76:79], v[44:47], v[100:103], v[76:79]
    ds_read_b128 v[100:103], v35 offset:14336
    s_waitcnt lgkmcnt(7)
    v_mfma_f32_16x16x32_bf16 v[80:83], v[44:47], v[104:107], v[80:83]
    ds_read_b128 v[104:107], v35 offset:30720
    s_waitcnt lgkmcnt(7)
    v_mfma_f32_16x16x32_bf16 v[76:79], v[48:51], v[108:111], v[76:79]
    ds_read_b128 v[108:111], v35 offset:15360
    s_waitcnt lgkmcnt(7)
    v_mfma_f32_16x16x32_bf16 v[80:83], v[48:51], v[112:115], v[80:83]
    ds_read_b128 v[112:115], v35 offset:31744
    s_waitcnt lgkmcnt(7)
    v_mfma_f32_16x16x32_bf16 v[76:79], v[124:127], v[84:87], v[76:79]
    s_waitcnt lgkmcnt(6)
    v_mfma_f32_16x16x32_bf16 v[80:83], v[124:127], v[88:91], v[80:83]
    s_waitcnt lgkmcnt(5)
    v_mfma_f32_16x16x32_bf16 v[76:79], v[128:131], v[92:95], v[76:79]
    s_waitcnt lgkmcnt(4)
    v_mfma_f32_16x16x32_bf16 v[80:83], v[128:131], v[96:99], v[80:83]
    ds_read_b64_tr_b16 v[208:209], v12 offset:0
    ds_read_b64_tr_b16 v[210:211], v12 offset:1024
    ds_read_b64_tr_b16 v[212:213], v12 offset:8192
    ds_read_b64_tr_b16 v[214:215], v12 offset:9216
    ds_read_b64_tr_b16 v[216:217], v12 offset:16384
    ds_read_b64_tr_b16 v[218:219], v12 offset:17408
    ds_read_b64_tr_b16 v[220:221], v12 offset:24576
    ds_read_b64_tr_b16 v[222:223], v12 offset:25600
    s_waitcnt lgkmcnt(11)
    v_mfma_f32_16x16x32_bf16 v[76:79], v[68:71], v[100:103], v[76:79]
    s_waitcnt lgkmcnt(10)
    v_mfma_f32_16x16x32_bf16 v[80:83], v[68:71], v[104:107], v[80:83]
    s_waitcnt lgkmcnt(9)
    v_mfma_f32_16x16x32_bf16 v[76:79], v[72:75], v[108:111], v[76:79]
    s_waitcnt lgkmcnt(8)
    v_mfma_f32_16x16x32_bf16 v[80:83], v[72:75], v[112:115], v[80:83]
    s_nop 5
    v_cvt_pk_bf16_f32 v132, v76, v77
    v_cvt_pk_bf16_f32 v133, v78, v79
    v_cvt_pk_bf16_f32 v134, v80, v81
    v_cvt_pk_bf16_f32 v135, v82, v83
    v_mov_b32 v6, 0
    v_mov_b32 v7, 0
    v_permlane32_swap_b32 v132, v134
    v_permlane32_swap_b32 v133, v135
    buffer_store_dwordx4 v[132:135], v8, s[32:35], s44 offen sc1
    v_dot2c_f32_bf16 v6, v132, v14
    v_dot2c_f32_bf16 v7, v132, v132
    v_dot2c_f32_bf16 v6, v133, v14
    v_dot2c_f32_bf16 v7, v133, v133
    v_dot2c_f32_bf16 v6, v134, v14
    v_dot2c_f32_bf16 v7, v134, v134
    v_dot2c_f32_bf16 v6, v135, v14
    v_dot2c_f32_bf16 v7, v135, v135
    s_nop 2
    v_permlane16_swap_b32 v6, v7
    v_add_f32 v6, v6, v7
    s_nop 1
    v_mov_b32 v26, v6 quad_perm:[0,0,0,0] row_mask:0xf bank_mask:0xf
    v_mov_b32 v27, v6 quad_perm:[1,1,1,1] row_mask:0xf bank_mask:0xf
    v_mov_b32 v28, v6 quad_perm:[2,2,2,2] row_mask:0xf bank_mask:0xf
    v_mov_b32 v29, v6 quad_perm:[3,3,3,3] row_mask:0xf bank_mask:0xf
    s_mov_b32 exec_lo, 0x11111111
    s_mov_b32 exec_hi, 0x11111111
    buffer_store_dwordx4 v[26:29], v9, s[32:35], s42 offen sc1
    s_mov_b64 exec, -1
    s_lshl_b32 s41, s4, 11
    s_add_u32 s41, s41, 65536
    s_lshl_b32 s54, s49, 7
    s_add_u32 s54, s54, s41
    v_add_u32 v12, 131072, v12
    ds_read_b64_tr_b16 v[224:225], v13 offset:32768
    ds_read_b64_tr_b16 v[226:227], v13 offset:33792
    ds_read_b64_tr_b16 v[228:229], v13 offset:40960
    ds_read_b64_tr_b16 v[230:231], v13 offset:41984
    ds_read_b64_tr_b16 v[232:233], v13 offset:49152
    ds_read_b64_tr_b16 v[234:235], v13 offset:50176
    ds_read_b64_tr_b16 v[236:237], v13 offset:57344
    ds_read_b64_tr_b16 v[238:239], v13 offset:58368
    ds_read_b64_tr_b16 v[240:241], v12 offset:0
    ds_read_b64_tr_b16 v[242:243], v12 offset:1024
    ds_read_b64_tr_b16 v[244:245], v12 offset:8192
    ds_read_b64_tr_b16 v[246:247], v12 offset:9216
    ds_read_b64_tr_b16 v[248:249], v12 offset:16384
    ds_read_b64_tr_b16 v[250:251], v12 offset:17408
    ds_read_b64_tr_b16 v[252:253], v12 offset:24576
    ds_read_b64_tr_b16 v[254:255], v12 offset:25600
    v_lshlrev_b32 v10, 3, v4
    v_lshlrev_b32 v143, 3, v1
    s_waitcnt lgkmcnt(15)
    v_mfma_f32_16x16x32_bf16 v[18:21], v[208:211], v[14:17], v[18:21]
    v_mfma_f32_16x16x32_bf16 v[22:25], v[212:215], v[14:17], v[22:25]
    v_mfma_f32_16x16x32_bf16 v[18:21], v[216:219], v[14:17], v[18:21]
    v_mfma_f32_16x16x32_bf16 v[22:25], v[220:223], v[14:17], v[22:25]
    s_and_b32 s36, s3, 1
    s_lshl1_add_u32 s36, s4, s36
    s_mul_i32 s50, s36, 57344
    s_add_u32 s50, s50, 4194304
    s_lshr_b32 s36, s3, 1
    s_lshl1_add_u32 s36, s57, s36
    s_lshl_b32 s56, s36, 10
    s_sub_u32 s36, s56, 14336
    s_cselect_b32 s56, s56, s36
    s_mul_i32 s60, s62, 14336
    s_sub_u32 s61, 14336, s60
    s_lshl_b32 s63, s3, 10
    s_mul_i32 s58, s3, 12288
    s_add_u32 s58, s58, 57344
    s_mul_i32 s51, s3, 200704
    s_lshl_b32 s36, s7, 7
    s_add_u32 s51, s51, s36
    s_lshl3_add_u32 s45, s4, s3
    s_lshl_b32 s45, s45, 12
    s_add_u32 s45, s45, 3145728
    s_lshl3_add_u32 s47, s46, s3
    s_mul_i32 s47, s47, 7168
    s_add_u32 s47, s47, 6291456
    s_waitcnt lgkmcnt(8)
    v_mfma_f32_16x16x32_bf16 v[18:21], v[224:227], v[14:17], v[18:21]
    v_mfma_f32_16x16x32_bf16 v[22:25], v[228:231], v[14:17], v[22:25]
    v_mfma_f32_16x16x32_bf16 v[18:21], v[232:235], v[14:17], v[18:21]
    v_mfma_f32_16x16x32_bf16 v[22:25], v[236:239], v[14:17], v[22:25]
    s_waitcnt lgkmcnt(0)
    v_mfma_f32_16x16x32_bf16 v[18:21], v[240:243], v[14:17], v[18:21]
    v_mfma_f32_16x16x32_bf16 v[22:25], v[244:247], v[14:17], v[22:25]
    v_mfma_f32_16x16x32_bf16 v[18:21], v[248:251], v[14:17], v[18:21]
    v_mfma_f32_16x16x32_bf16 v[22:25], v[252:255], v[14:17], v[22:25]
    s_waitcnt vmcnt(0)
    s_barrier
    s_cmp_eq_u32 s3, 0
    s_cbranch_scc0 .Lfl_42
    s_mov_b64 exec, 0xff
    buffer_store_dwordx4 v[4:7], v4, s[32:35], s54 offen offset:0 sc1
    s_mov_b64 exec, -1
.Lfl_42:
    s_mul_i32 s42, s4, 458752
    s_lshl3_add_u32 s36, s6, s3
    s_lshl_b32 s37, s36, 9
    s_add_u32 s42, s42, s37
    s_add_u32 s42, s42, 6291456
    s_mul_i32 s44, s4, 57344
    s_add_u32 s44, s44, 15728640
    s_lshl_b32 s54, s36, 7
    s_add_u32 s54, s54, s44
    s_mul_i32 s36, s3, 1792
    s_add_u32 s44, s44, s36
    v_lshrrev_b32 v7, 5, v1
    v_mul_u32_u24 v7, 228864, v7
    v_add_u32 v7, v7, v4
    s_and_b32 s36, s3, 3
    s_lshl_b32 s36, s36, 5
    v_and_b32 v6, 0xfff, v12
    v_xor_b32 v6, s36, v6
    v_add_u32 v6, s58, v6
    s_lshl_b32 s36, s3, 7
    s_add_u32 s36, s36, 155648
    v_lshrrev_b32 v13, 5, v1
    v_lshl_add_u32 v13, v2, 1, v13
    v_lshl_add_u32 v13, v13, 3, s36
    s_add_u32 m0, s58, 0
    s_add_u32 s52, s51, 0
    buffer_load_dwordx4 v11, s[24:27], s52 offen offset:0 lds
    s_add_u32 m0, s58, 0
    s_add_u32 s52, s51, 6144
    buffer_load_dwordx4 v11, s[24:27], s52 offen offset:1024 lds
    s_add_u32 m0, s58, 0
    s_add_u32 s52, s51, 12288
    buffer_load_dwordx4 v11, s[24:27], s52 offen offset:2048 lds
    s_add_u32 m0, s58, 0
    s_add_u32 s52, s51, 18432
    buffer_load_dwordx4 v11, s[24:27], s52 offen offset:3072 lds
    s_add_u32 m0, s58, 4096
    s_add_u32 s52, s51, 28672
    buffer_load_dwordx4 v11, s[24:27], s52 offen offset:0 lds
    s_add_u32 m0, s58, 4096
    s_add_u32 s52, s51, 34816
    buffer_load_dwordx4 v11, s[24:27], s52 offen offset:1024 lds
    s_add_u32 m0, s58, 4096
    s_add_u32 s52, s51, 40960
    buffer_load_dwordx4 v11, s[24:27], s52 offen offset:2048 lds
    s_add_u32 m0, s58, 4096
    s_add_u32 s52, s51, 47104
    buffer_load_dwordx4 v11, s[24:27], s52 offen offset:3072 lds
    v_lshlrev_b32 v12, 3, v2
    v_add_u32 v12, 155648, v12
    v_xor_b32 v14, 0, v6
    v_xor_b32 v15, 32, v6
    v_xor_b32 v16, 64, v6
    v_xor_b32 v17, 96, v6
    v_cvt_pk_bf16_f32 v1, v76, v77
    v_cvt_pk_bf16_f32 v2, v78, v79
    v_cvt_pk_bf16_f32 v3, v80, v81
    v_cvt_pk_bf16_f32 v6, v82, v83
    s_mov_b64 exec, 0x00003fff
    buffer_load_dword v0, v10, s[32:35], s41 offen offset:4 sc1
    s_mov_b64 exec, -1
    s_waitcnt vmcnt(0)
    s_mov_b64 exec, 0x00003fff
.Lpw_43:
    v_cmp_ne_u32 vcc, v0, v5
    s_and_b64 exec, exec, vcc
    s_cbranch_scc0 .Lpd_44
    buffer_load_dword v0, v10, s[32:35], s41 offen offset:4 sc1
    s_sub_u32 s48, s48, 1
    s_waitcnt vmcnt(0)
    s_cbranch_scc0 .Lpw_43
    s_mov_b32 s48, 0
.Lpd_44:
    s_mov_b64 exec, -1
    s_add_u32 m0, s63, 0
    s_add_u32 s36, s50, s56
    buffer_load_dwordx4 v4, s[32:35], s36 offen sc1 lds
    s_add_u32 s56, s56, 4096
    s_sub_u32 s36, s56, 14336
    s_cselect_b32 s56, s56, s36
    s_add_u32 m0, s63, 8192
    s_add_u32 s36, s50, s56
    buffer_load_dwordx4 v4, s[32:35], s36 offen sc1 lds
    s_add_u32 s56, s56, 4096
    s_sub_u32 s36, s56, 14336
    s_cselect_b32 s56, s56, s36
    buffer_load_dwordx2 v[126:127], v143, s[32:35], s45 offen offset:0 sc1
    buffer_load_dwordx2 v[128:129], v143, s[32:35], s45 offen offset:512 sc1
    buffer_load_dwordx2 v[130:131], v143, s[32:35], s45 offen offset:1024 sc1
    buffer_load_dwordx2 v[132:133], v143, s[32:35], s45 offen offset:1536 sc1
    buffer_load_dwordx2 v[134:135], v143, s[32:35], s45 offen offset:2048 sc1
    buffer_load_dwordx2 v[136:137], v143, s[32:35], s45 offen offset:2560 sc1
    buffer_load_dwordx2 v[138:139], v143, s[32:35], s45 offen offset:3072 sc1
    s_add_u32 m0, s63, 16384
    s_add_u32 s36, s50, s56
    buffer_load_dwordx4 v4, s[32:35], s36 offen sc1 lds
    s_add_u32 s56, s56, 4096
    s_sub_u32 s36, s56, 14336
    s_cselect_b32 s56, s56, s36
    s_add_u32 m0, s63, 24576
    s_add_u32 s50, s50, s60
    s_add_u32 s36, s50, s56
    buffer_load_dwordx4 v4, s[32:35], s36 offen sc1 lds
    s_add_u32 s56, s56, 4096
    s_sub_u32 s36, s56, 14336
    s_cselect_b32 s56, s56, s36
    s_waitcnt vmcnt(9)
    s_barrier
    ds_read_b128 v[26:29], v4 offset:0
    ds_read_b128 v[30:33], v4 offset:1024
    ds_read_b128 v[34:37], v4 offset:2048
    ds_read_b128 v[38:41], v4 offset:3072
    s_waitcnt lgkmcnt(3)
    v_mfma_f32_16x16x32_bf16 v[46:49], v[144:147], v[26:29], 0
    ds_read_b128 v[42:45], v4 offset:4096
    v_mfma_f32_16x16x32_bf16 v[50:53], v[148:151], v[26:29], 0
    s_waitcnt lgkmcnt(3)
    v_mfma_f32_16x16x32_bf16 v[54:57], v[144:147], v[30:33], 0
    ds_read_b128 v[26:29], v4 offset:5120
    s_add_u32 m0, s63, 32768
    s_add_u32 s50, s50, s61
    s_add_u32 s36, s50, s56
    buffer_load_dwordx4 v4, s[32:35], s36 offen sc1 lds
    s_add_u32 s56, s56, 4096
    s_sub_u32 s36, s56, 14336
    s_cselect_b32 s56, s56, s36
    v_mfma_f32_16x16x32_bf16 v[58:61], v[148:151], v[30:33], 0
    s_waitcnt lgkmcnt(3)
    v_mfma_f32_16x16x32_bf16 v[46:49], v[152:155], v[34:37], v[46:49]
    ds_read_b128 v[30:33], v4 offset:6144
    v_mfma_f32_16x16x32_bf16 v[50:53], v[156:159], v[34:37], v[50:53]
    s_waitcnt lgkmcnt(3)
    v_mfma_f32_16x16x32_bf16 v[54:57], v[152:155], v[38:41], v[54:57]
    ds_read_b128 v[34:37], v4 offset:7168
    s_add_u32 m0, s63, 40960
    s_add_u32 s36, s50, s56
    buffer_load_dwordx4 v4, s[32:35], s36 offen sc1 lds
    s_add_u32 s56, s56, 4096
    s_sub_u32 s36, s56, 14336
    s_cselect_b32 s56, s56, s36
    v_mfma_f32_16x16x32_bf16 v[58:61], v[156:159], v[38:41], v[58:61]
    s_waitcnt lgkmcnt(3)
    v_mfma_f32_16x16x32_bf16 v[46:49], v[160:163], v[42:45], v[46:49]
    ds_read_b128 v[38:41], v4 offset:8192
    v_mfma_f32_16x16x32_bf16 v[50:53], v[164:167], v[42:45], v[50:53]
    s_waitcnt lgkmcnt(3)
    v_mfma_f32_16x16x32_bf16 v[54:57], v[160:163], v[26:29], v[54:57]
    ds_read_b128 v[42:45], v4 offset:9216
    s_add_u32 m0, s63, 49152
    s_add_u32 s36, s50, s56
    buffer_load_dwordx4 v4, s[32:35], s36 offen sc1 lds
    s_add_u32 s56, s56, 4096
    s_sub_u32 s36, s56, 14336
    s_cselect_b32 s56, s56, s36
    v_mfma_f32_16x16x32_bf16 v[58:61], v[164:167], v[26:29], v[58:61]
    s_waitcnt lgkmcnt(3)
    v_mfma_f32_16x16x32_bf16 v[46:49], v[168:171], v[30:33], v[46:49]
    ds_read_b128 v[26:29], v4 offset:10240
    v_mfma_f32_16x16x32_bf16 v[50:53], v[172:175], v[30:33], v[50:53]
    ds_read_b64_tr_b16 v[78:79], v14 offset:0
    s_waitcnt lgkmcnt(4)
    v_mfma_f32_16x16x32_bf16 v[54:57], v[168:171], v[34:37], v[54:57]
    ds_read_b128 v[30:33], v4 offset:11264
    ds_read_b64_tr_b16 v[80:81], v14 offset:1024
    v_mfma_f32_16x16x32_bf16 v[58:61], v[172:175], v[34:37], v[58:61]
    ds_read_b64_tr_b16 v[82:83], v15 offset:0
    s_waitcnt lgkmcnt(6)
    v_mfma_f32_16x16x32_bf16 v[46:49], v[176:179], v[38:41], v[46:49]
    ds_read_b128 v[34:37], v4 offset:12288
    ds_read_b64_tr_b16 v[84:85], v15 offset:1024
    v_mfma_f32_16x16x32_bf16 v[50:53], v[180:183], v[38:41], v[50:53]
    ds_read_b64_tr_b16 v[86:87], v16 offset:0
    s_waitcnt lgkmcnt(8)
    v_mfma_f32_16x16x32_bf16 v[54:57], v[176:179], v[42:45], v[54:57]
    ds_read_b128 v[38:41], v4 offset:13312
    ds_read_b64_tr_b16 v[88:89], v16 offset:1024
    v_mfma_f32_16x16x32_bf16 v[58:61], v[180:183], v[42:45], v[58:61]
    ds_read_b64_tr_b16 v[90:91], v17 offset:0
    s_waitcnt lgkmcnt(10)
    v_mfma_f32_16x16x32_bf16 v[46:49], v[184:187], v[26:29], v[46:49]
    ds_read_b128 v[42:45], v4 offset:14336
    ds_read_b64_tr_b16 v[92:93], v17 offset:1024
    v_mfma_f32_16x16x32_bf16 v[50:53], v[188:191], v[26:29], v[50:53]
    s_add_u32 m0, s58, 8192
    s_add_u32 s52, s51, 57344
    buffer_load_dwordx4 v11, s[24:27], s52 offen offset:0 lds
    s_add_u32 m0, s58, 8192
    s_add_u32 s52, s51, 63488
    buffer_load_dwordx4 v11, s[24:27], s52 offen offset:1024 lds
    s_waitcnt lgkmcnt(10)
    v_mfma_f32_16x16x32_bf16 v[54:57], v[184:187], v[30:33], v[54:57]
    ds_read_b128 v[26:29], v4 offset:15360
    s_add_u32 m0, s58, 8192
    s_add_u32 s52, s51, 69632
    buffer_load_dwordx4 v11, s[24:27], s52 offen offset:2048 lds
    v_mfma_f32_16x16x32_bf16 v[58:61], v[188:191], v[30:33], v[58:61]
    s_waitcnt vmcnt(6) lgkmcnt(8)
    s_barrier
    v_mfma_f32_16x16x32_bf16 v[46:49], v[192:195], v[34:37], v[46:49]
    ds_read_b128 v[30:33], v4 offset:16384
    s_add_u32 m0, s63, 0
    s_add_u32 s50, s50, 14336
    s_add_u32 s36, s50, s56
    buffer_load_dwordx4 v4, s[32:35], s36 offen sc1 lds
    s_add_u32 s56, s56, 4096
    s_sub_u32 s36, s56, 14336
    s_cselect_b32 s56, s56, s36
    v_mfma_f32_16x16x32_bf16 v[50:53], v[196:199], v[34:37], v[50:53]
    s_waitcnt lgkmcnt(6)
    v_mfma_f32_16x16x32_bf16 v[54:57], v[192:195], v[38:41], v[54:57]
    ds_read_b128 v[34:37], v4 offset:17408
    v_add_f32 v126, v126, v128
    v_mfma_f32_16x16x32_bf16 v[58:61], v[196:199], v[38:41], v[58:61]
    v_add_f32 v127, v127, v129
    v_add_f32 v130, v130, v132
    s_waitcnt lgkmcnt(4)
    v_mfma_f32_16x16x32_bf16 v[46:49], v[200:203], v[42:45], v[46:49]
    ds_read_b128 v[38:41], v4 offset:18432
    v_add_f32 v131, v131, v133
    v_add_f32 v134, v134, v136
    v_mfma_f32_16x16x32_bf16 v[50:53], v[204:207], v[42:45], v[50:53]
    v_add_f32 v135, v135, v137
    v_add_f32 v126, v126, v130
    s_waitcnt lgkmcnt(3)
    v_mfma_f32_16x16x32_bf16 v[54:57], v[200:203], v[26:29], v[54:57]
    ds_read_b128 v[42:45], v4 offset:19456
    v_add_f32 v127, v127, v131
    v_add_f32 v134, v134, v138
    v_mfma_f32_16x16x32_bf16 v[58:61], v[204:207], v[26:29], v[58:61]
    v_add_f32 v135, v135, v139
    v_add_f32 v126, v126, v134
    s_waitcnt lgkmcnt(3)
    v_mfma_f32_16x16x32_bf16 v[46:49], v[208:211], v[30:33], v[46:49]
    ds_read_b128 v[26:29], v4 offset:20480
    v_add_f32 v127, v127, v135
    v_mov_b32 v140, 0x3727c5ac
    v_mfma_f32_16x16x32_bf16 v[50:53], v[212:215], v[30:33], v[50:53]
    v_permlane32_swap_b32 v126, v127
    v_add_f32 v126, v126, v127
    s_waitcnt lgkmcnt(3)
    v_mfma_f32_16x16x32_bf16 v[54:57], v[208:211], v[34:37], v[54:57]
    ds_read_b128 v[30:33], v4 offset:21504
    v_mov_b32 v127, v126
    s_nop 1
    v_permlane16_swap_b32 v126, v127
    v_mfma_f32_16x16x32_bf16 v[58:61], v[212:215], v[34:37], v[58:61]
    v_add_f32 v126, v126, v127
    v_mul_f32 v126, s55, v126
    s_waitcnt lgkmcnt(3)
    v_mfma_f32_16x16x32_bf16 v[46:49], v[216:219], v[38:41], v[46:49]
    ds_read_b128 v[34:37], v4 offset:22528
    v_add_f32 v127, v126, v140 row_ror:8 row_mask:0xf bank_mask:0xf
    v_fma_f32 v127, -v126, v126, v127
    v_mfma_f32_16x16x32_bf16 v[50:53], v[220:223], v[38:41], v[50:53]
    v_max_f32 v127, v127, v140
    v_rcp_f32 v127, v127
    s_waitcnt lgkmcnt(3)
    v_mfma_f32_16x16x32_bf16 v[54:57], v[216:219], v[42:45], v[54:57]
    ds_read_b128 v[38:41], v4 offset:23552
    v_xor_b32 v126, 0x80000000, v126
    s_mov_b32 exec_lo, 0x000000ff
    s_mov_b32 exec_hi, 0x000000ff
    ds_write_b64 v13, v[126:127]
    s_mov_b64 exec, -1
    v_mfma_f32_16x16x32_bf16 v[58:61], v[220:223], v[42:45], v[58:61]
    s_add_u32 m0, s58, 8192
    s_add_u32 s52, s51, 75776
    buffer_load_dwordx4 v11, s[24:27], s52 offen offset:3072 lds
    s_waitcnt lgkmcnt(4)
    v_mfma_f32_16x16x32_bf16 v[46:49], v[224:227], v[26:29], v[46:49]
    ds_read_b128 v[42:45], v4 offset:24576
    s_add_u32 m0, s58, 0
    s_add_u32 s52, s51, 86016
    buffer_load_dwordx4 v11, s[24:27], s52 offen offset:0 lds
    s_add_u32 m0, s58, 0
    s_add_u32 s52, s51, 92160
    buffer_load_dwordx4 v11, s[24:27], s52 offen offset:1024 lds
    v_mfma_f32_16x16x32_bf16 v[50:53], v[228:231], v[26:29], v[50:53]
    s_waitcnt lgkmcnt(4)
    v_mfma_f32_16x16x32_bf16 v[54:57], v[224:227], v[30:33], v[54:57]
    ds_read_b128 v[26:29], v4 offset:25600
    ds_read_b64_tr_b16 v[94:95], v14 offset:4096
    v_mfma_f32_16x16x32_bf16 v[58:61], v[228:231], v[30:33], v[58:61]
    ds_read_b64_tr_b16 v[96:97], v14 offset:5120
    s_waitcnt lgkmcnt(6)
    v_mfma_f32_16x16x32_bf16 v[46:49], v[232:235], v[34:37], v[46:49]
    ds_read_b128 v[30:33], v4 offset:26624
    ds_read_b64_tr_b16 v[98:99], v15 offset:4096
    v_mfma_f32_16x16x32_bf16 v[50:53], v[236:239], v[34:37], v[50:53]
    ds_read_b64_tr_b16 v[100:101], v15 offset:5120
    s_waitcnt lgkmcnt(8)
    v_mfma_f32_16x16x32_bf16 v[54:57], v[232:235], v[38:41], v[54:57]
    ds_read_b128 v[34:37], v4 offset:27648
    ds_read_b64_tr_b16 v[102:103], v16 offset:4096
    v_mfma_f32_16x16x32_bf16 v[58:61], v[236:239], v[38:41], v[58:61]
    ds_read_b64_tr_b16 v[104:105], v16 offset:5120
    s_waitcnt lgkmcnt(9)
    v_mfma_f32_16x16x32_bf16 v[46:49], v[240:243], v[42:45], v[46:49]
    ds_read_b128 v[38:41], v4 offset:28672
    ds_read_b64_tr_b16 v[106:107], v17 offset:4096
    v_mfma_f32_16x16x32_bf16 v[50:53], v[244:247], v[42:45], v[50:53]
    ds_read_b64_tr_b16 v[108:109], v17 offset:5120
    s_waitcnt lgkmcnt(11)
    v_mfma_f32_16x16x32_bf16 v[54:57], v[240:243], v[26:29], v[54:57]
    ds_read_b128 v[42:45], v4 offset:29696
    s_add_u32 m0, s58, 0
    s_add_u32 s52, s51, 98304
    buffer_load_dwordx4 v11, s[24:27], s52 offen offset:2048 lds
    s_add_u32 m0, s58, 0
    s_add_u32 s52, s51, 104448
    buffer_load_dwordx4 v11, s[24:27], s52 offen offset:3072 lds
    v_mfma_f32_16x16x32_bf16 v[58:61], v[244:247], v[26:29], v[58:61]
    s_waitcnt lgkmcnt(9)
    v_mfma_f32_16x16x32_bf16 v[46:49], v[248:251], v[30:33], v[46:49]
    ds_read_b128 v[26:29], v4 offset:30720
    v_mfma_f32_16x16x32_bf16 v[50:53], v[252:255], v[30:33], v[50:53]
    s_waitcnt lgkmcnt(7)
    v_mfma_f32_16x16x32_bf16 v[54:57], v[248:251], v[34:37], v[54:57]
    ds_read_b128 v[30:33], v4 offset:31744
    v_mfma_f32_16x16x32_bf16 v[58:61], v[252:255], v[34:37], v[58:61]
    s_waitcnt vmcnt(10) lgkmcnt(5)
    s_barrier
    v_mfma_f32_16x16x32_bf16 v[62:65], v[144:147], v[38:41], 0
    ds_read_b128 v[34:37], v4 offset:32768
    s_add_u32 m0, s63, 8192
    s_add_u32 s36, s50, s56
    buffer_load_dwordx4 v4, s[32:35], s36 offen sc1 lds
    s_add_u32 s56, s56, 4096
    s_sub_u32 s36, s56, 14336
    s_cselect_b32 s56, s56, s36
    ds_read2_b32 v[8:9], v12 offset0:0 offset1:128
    v_mfma_f32_16x16x32_bf16 v[66:69], v[148:151], v[38:41], 0
    s_waitcnt lgkmcnt(4)
    v_mfma_f32_16x16x32_bf16 v[70:73], v[144:147], v[42:45], 0
    ds_read_b128 v[38:41], v4 offset:33792
    v_mfma_f32_16x16x32_bf16 v[74:77], v[148:151], v[42:45], 0
    s_waitcnt lgkmcnt(4)
    v_mfma_f32_16x16x32_bf16 v[62:65], v[152:155], v[26:29], v[62:65]
    ds_read_b128 v[42:45], v4 offset:34816
    s_add_u32 m0, s63, 16384
    s_add_u32 s36, s50, s56
    buffer_load_dwordx4 v4, s[32:35], s36 offen sc1 lds
    s_add_u32 s56, s56, 4096
    s_sub_u32 s36, s56, 14336
    s_cselect_b32 s56, s56, s36
    s_waitcnt lgkmcnt(2)
    v_mfma_f32_16x16x32_bf16 v[66:69], v[156:159], v[26:29], v[66:69]
    v_fmac_f32 v46, v8, v18
    v_fmac_f32 v50, v8, v22
    v_fmac_f32 v47, v8, v19
    v_mfma_f32_16x16x32_bf16 v[70:73], v[152:155], v[30:33], v[70:73]
    ds_read_b128 v[26:29], v4 offset:35840
    v_fmac_f32 v51, v8, v23
    v_fmac_f32 v48, v8, v20
    v_fmac_f32 v52, v8, v24
    v_mfma_f32_16x16x32_bf16 v[74:77], v[156:159], v[30:33], v[74:77]
    v_fmac_f32 v49, v8, v21
    v_fmac_f32 v53, v8, v25
    v_mul_f32 v46, v46, v50
    v_mfma_f32_16x16x32_bf16 v[62:65], v[160:163], v[34:37], v[62:65]
    ds_read_b128 v[30:33], v4 offset:36864
    v_mul_f32 v47, v47, v51
    v_mul_f32 v48, v48, v52
    v_mul_f32 v49, v49, v53
    v_mfma_f32_16x16x32_bf16 v[66:69], v[164:167], v[34:37], v[66:69]
    v_cvt_pk_bf16_f32 v50, v46, v47
    v_cvt_pk_bf16_f32 v51, v48, v49
    v_fmac_f32 v54, v9, v18
    s_waitcnt lgkmcnt(3)
    v_mfma_f32_16x16x32_bf16 v[70:73], v[160:163], v[38:41], v[70:73]
    ds_read_b128 v[34:37], v4 offset:37888
    v_fmac_f32 v58, v9, v22
    v_fmac_f32 v55, v9, v19
    v_fmac_f32 v59, v9, v23
    v_mfma_f32_16x16x32_bf16 v[74:77], v[164:167], v[38:41], v[74:77]
    v_fmac_f32 v56, v9, v20
    v_fmac_f32 v60, v9, v24
    v_fmac_f32 v57, v9, v21
    s_waitcnt lgkmcnt(3)
    v_mfma_f32_16x16x32_bf16 v[62:65], v[168:171], v[42:45], v[62:65]
    ds_read_b128 v[38:41], v4 offset:38912
    v_fmac_f32 v61, v9, v25
    v_mul_f32 v54, v54, v58
    v_mul_f32 v55, v55, v59
    v_mfma_f32_16x16x32_bf16 v[66:69], v[172:175], v[42:45], v[66:69]
    v_mul_f32 v56, v56, v60
    v_mul_f32 v57, v57, v61
    v_cvt_pk_bf16_f32 v52, v54, v55
    s_waitcnt lgkmcnt(3)
    v_mfma_f32_16x16x32_bf16 v[70:73], v[168:171], v[26:29], v[70:73]
    ds_read_b128 v[42:45], v4 offset:39936
    v_cvt_pk_bf16_f32 v53, v56, v57
    s_add_u32 s45, s42, 0
    v_permlane32_swap_b32 v50, v52
    v_mfma_f32_16x16x32_bf16 v[74:77], v[172:175], v[26:29], v[74:77]
    v_permlane32_swap_b32 v51, v53
    buffer_store_dwordx4 v[50:53], v7, s[32:35], s45 offen sc1
    s_waitcnt lgkmcnt(3)
    v_mfma_f32_16x16x32_bf16 v[62:65], v[176:179], v[30:33], v[62:65]
    ds_read_b128 v[26:29], v4 offset:40960
    s_add_u32 m0, s58, 4096
    s_add_u32 s52, s51, 114688
    buffer_load_dwordx4 v11, s[24:27], s52 offen offset:0 lds
    s_add_u32 m0, s58, 4096
    s_add_u32 s52, s51, 120832
    buffer_load_dwordx4 v11, s[24:27], s52 offen offset:1024 lds
    v_mfma_f32_16x16x32_bf16 v[66:69], v[180:183], v[30:33], v[66:69]
    s_waitcnt lgkmcnt(3)
    v_mfma_f32_16x16x32_bf16 v[70:73], v[176:179], v[34:37], v[70:73]
    ds_read_b128 v[30:33], v4 offset:41984
    v_mfma_f32_16x16x32_bf16 v[74:77], v[180:183], v[34:37], v[74:77]
    s_waitcnt lgkmcnt(3)
    v_mfma_f32_16x16x32_bf16 v[62:65], v[184:187], v[38:41], v[62:65]
    ds_read_b128 v[34:37], v4 offset:43008
    v_mfma_f32_16x16x32_bf16 v[66:69], v[188:191], v[38:41], v[66:69]
    s_waitcnt lgkmcnt(3)
    v_mfma_f32_16x16x32_bf16 v[70:73], v[184:187], v[42:45], v[70:73]
    ds_read_b128 v[38:41], v4 offset:44032
    s_add_u32 m0, s58, 4096
    s_add_u32 s52, s51, 126976
    buffer_load_dwordx4 v11, s[24:27], s52 offen offset:2048 lds
    v_mfma_f32_16x16x32_bf16 v[74:77], v[188:191], v[42:45], v[74:77]
    s_waitcnt lgkmcnt(3)
    v_mfma_f32_16x16x32_bf16 v[62:65], v[192:195], v[26:29], v[62:65]
    ds_read_b128 v[42:45], v4 offset:45056
    s_waitcnt vmcnt(10)
    v_mfma_f32_16x16x32_bf16 v[66:69], v[196:199], v[26:29], v[66:69]
    ds_read_b64_tr_b16 v[110:111], v14 offset:8192
    s_waitcnt lgkmcnt(4)
    v_mfma_f32_16x16x32_bf16 v[70:73], v[192:195], v[30:33], v[70:73]
    ds_read_b128 v[26:29], v4 offset:46080
    ds_read_b64_tr_b16 v[112:113], v14 offset:9216
    v_mfma_f32_16x16x32_bf16 v[74:77], v[196:199], v[30:33], v[74:77]
    ds_read_b64_tr_b16 v[114:115], v15 offset:8192
    s_waitcnt lgkmcnt(6)
    v_mfma_f32_16x16x32_bf16 v[62:65], v[200:203], v[34:37], v[62:65]
    ds_read_b128 v[30:33], v4 offset:47104
    ds_read_b64_tr_b16 v[116:117], v15 offset:9216
    v_mfma_f32_16x16x32_bf16 v[66:69], v[204:207], v[34:37], v[66:69]
    ds_read_b64_tr_b16 v[118:119], v16 offset:8192
    s_waitcnt lgkmcnt(8)
    v_mfma_f32_16x16x32_bf16 v[70:73], v[200:203], v[38:41], v[70:73]
    ds_read_b128 v[34:37], v4 offset:48128
    ds_read_b64_tr_b16 v[120:121], v16 offset:9216
    v_mfma_f32_16x16x32_bf16 v[74:77], v[204:207], v[38:41], v[74:77]
    ds_read_b64_tr_b16 v[122:123], v17 offset:8192
    s_waitcnt lgkmcnt(10)
    s_barrier
    v_mfma_f32_16x16x32_bf16 v[62:65], v[208:211], v[42:45], v[62:65]
    ds_read_b128 v[38:41], v4 offset:49152
    ds_read_b64_tr_b16 v[124:125], v17 offset:9216
    v_mfma_f32_16x16x32_bf16 v[66:69], v[212:215], v[42:45], v[66:69]
    s_add_u32 m0, s58, 4096
    s_add_u32 s52, s51, 133120
    buffer_load_dwordx4 v11, s[24:27], s52 offen offset:3072 lds
    s_add_u32 m0, s63, 24576
    s_add_u32 s50, s50, s60
    s_add_u32 s36, s50, s56
    buffer_load_dwordx4 v4, s[32:35], s36 offen sc1 lds
    s_add_u32 s56, s56, 4096
    s_sub_u32 s36, s56, 14336
    s_cselect_b32 s56, s56, s36
    s_waitcnt lgkmcnt(10)
    v_mfma_f32_16x16x32_bf16 v[70:73], v[208:211], v[26:29], v[70:73]
    ds_read_b128 v[42:45], v4 offset:50176
    v_mfma_f32_16x16x32_bf16 v[74:77], v[212:215], v[26:29], v[74:77]
    s_waitcnt lgkmcnt(8)
    v_mfma_f32_16x16x32_bf16 v[62:65], v[216:219], v[30:33], v[62:65]
    ds_read_b128 v[26:29], v4 offset:51200
    s_add_u32 m0, s63, 32768
    s_add_u32 s50, s50, s61
    s_add_u32 s36, s50, s56
    buffer_load_dwordx4 v4, s[32:35], s36 offen sc1 lds
    s_add_u32 s56, s56, 4096
    s_sub_u32 s36, s56, 14336
    s_cselect_b32 s56, s56, s36
    v_mfma_f32_16x16x32_bf16 v[66:69], v[220:223], v[30:33], v[66:69]
    s_waitcnt lgkmcnt(6)
    v_mfma_f32_16x16x32_bf16 v[70:73], v[216:219], v[34:37], v[70:73]
    ds_read_b128 v[30:33], v4 offset:52224
    v_mfma_f32_16x16x32_bf16 v[74:77], v[220:223], v[34:37], v[74:77]
    s_waitcnt lgkmcnt(4)
    v_mfma_f32_16x16x32_bf16 v[62:65], v[224:227], v[38:41], v[62:65]
    ds_read_b128 v[34:37], v4 offset:53248
    v_mfma_f32_16x16x32_bf16 v[66:69], v[228:231], v[38:41], v[66:69]
    s_waitcnt lgkmcnt(3)
    v_mfma_f32_16x16x32_bf16 v[70:73], v[224:227], v[42:45], v[70:73]
    ds_read_b128 v[38:41], v4 offset:54272
    s_add_u32 m0, s58, 8192
    s_add_u32 s52, s51, 143360
    buffer_load_dwordx4 v11, s[24:27], s52 offen offset:0 lds
    v_mfma_f32_16x16x32_bf16 v[74:77], v[228:231], v[42:45], v[74:77]
    s_waitcnt lgkmcnt(3)
    v_mfma_f32_16x16x32_bf16 v[62:65], v[232:235], v[26:29], v[62:65]
    ds_read_b128 v[42:45], v4 offset:55296
    s_waitcnt vmcnt(10)
    v_mfma_f32_16x16x32_bf16 v[66:69], v[236:239], v[26:29], v[66:69]
    ds_read_b64_tr_b16 v[126:127], v14 offset:0
    s_waitcnt lgkmcnt(4)
    v_mfma_f32_16x16x32_bf16 v[70:73], v[232:235], v[30:33], v[70:73]
    ds_read_b128 v[26:29], v4 offset:56320
    ds_read_b64_tr_b16 v[128:129], v14 offset:1024
    v_mfma_f32_16x16x32_bf16 v[74:77], v[236:239], v[30:33], v[74:77]
    ds_read_b64_tr_b16 v[130:131], v15 offset:0
    s_waitcnt lgkmcnt(6)
    v_mfma_f32_16x16x32_bf16 v[62:65], v[240:243], v[34:37], v[62:65]
    ds_read_b128 v[30:33], v4 offset:0
    ds_read_b64_tr_b16 v[132:133], v15 offset:1024
    v_mfma_f32_16x16x32_bf16 v[66:69], v[244:247], v[34:37], v[66:69]
    ds_read_b64_tr_b16 v[134:135], v16 offset:0
    s_waitcnt lgkmcnt(8)
    v_mfma_f32_16x16x32_bf16 v[70:73], v[240:243], v[38:41], v[70:73]
    ds_read_b128 v[34:37], v4 offset:1024
    ds_read_b64_tr_b16 v[136:137], v16 offset:1024
    v_mfma_f32_16x16x32_bf16 v[74:77], v[244:247], v[38:41], v[74:77]
    ds_read_b64_tr_b16 v[138:139], v17 offset:0
    s_waitcnt lgkmcnt(10)
    v_mfma_f32_16x16x32_bf16 v[62:65], v[248:251], v[42:45], v[62:65]
    ds_read_b128 v[38:41], v4 offset:2048
    ds_read_b64_tr_b16 v[140:141], v17 offset:1024
    v_mfma_f32_16x16x32_bf16 v[66:69], v[252:255], v[42:45], v[66:69]
    s_waitcnt vmcnt(7)
    s_mov_b64 exec, 0xff
    buffer_store_dwordx4 v[4:7], v4, s[32:35], s54 offen offset:0 sc1
    s_mov_b64 exec, -1
    s_add_u32 s54, s54, 14336
    s_add_u32 m0, s58, 8192
    s_add_u32 s52, s51, 149504
    buffer_load_dwordx4 v11, s[24:27], s52 offen offset:1024 lds
    s_waitcnt lgkmcnt(10)
    v_mfma_f32_16x16x32_bf16 v[70:73], v[248:251], v[26:29], v[70:73]
    ds_read_b128 v[42:45], v4 offset:3072
    ds_read2_b32 v[8:9], v12 offset0:32 offset1:160
    s_add_u32 m0, s58, 8192
    s_add_u32 s52, s51, 155648
    buffer_load_dwordx4 v11, s[24:27], s52 offen offset:2048 lds
    v_mfma_f32_16x16x32_bf16 v[74:77], v[252:255], v[26:29], v[74:77]
    s_waitcnt lgkmcnt(9)
    v_mfma_f32_16x16x32_bf16 v[46:49], v[144:147], v[30:33], 0
    ds_read_b128 v[26:29], v4 offset:4096
    v_mfma_f32_16x16x32_bf16 v[50:53], v[148:151], v[30:33], 0
    s_waitcnt lgkmcnt(7)
    v_mfma_f32_16x16x32_bf16 v[54:57], v[144:147], v[34:37], 0
    ds_read_b128 v[30:33], v4 offset:5120
    s_waitcnt lgkmcnt(2)
    v_fmac_f32 v62, v8, v18
    v_fmac_f32 v66, v8, v22
    v_mfma_f32_16x16x32_bf16 v[58:61], v[148:151], v[34:37], 0
    v_fmac_f32 v63, v8, v19
    v_fmac_f32 v67, v8, v23
    v_fmac_f32 v64, v8, v20
    v_mfma_f32_16x16x32_bf16 v[46:49], v[152:155], v[38:41], v[46:49]
    ds_read_b128 v[34:37], v4 offset:6144
    v_fmac_f32 v68, v8, v24
    v_fmac_f32 v65, v8, v21
    v_fmac_f32 v69, v8, v25
    v_mfma_f32_16x16x32_bf16 v[50:53], v[156:159], v[38:41], v[50:53]
    v_mul_f32 v62, v62, v66
    v_mul_f32 v63, v63, v67
    v_mul_f32 v64, v64, v68
    v_mfma_f32_16x16x32_bf16 v[54:57], v[152:155], v[42:45], v[54:57]
    ds_read_b128 v[38:41], v4 offset:7168
    v_mul_f32 v65, v65, v69
    v_cvt_pk_bf16_f32 v66, v62, v63
    v_cvt_pk_bf16_f32 v67, v64, v65
    v_mfma_f32_16x16x32_bf16 v[58:61], v[156:159], v[42:45], v[58:61]
    v_fmac_f32 v70, v9, v18
    v_fmac_f32 v74, v9, v22
    v_fmac_f32 v71, v9, v19
    s_waitcnt lgkmcnt(3)
    s_barrier
    v_mfma_f32_16x16x32_bf16 v[46:49], v[160:163], v[26:29], v[46:49]
    ds_read_b128 v[42:45], v4 offset:8192
    v_fmac_f32 v75, v9, v23
    v_fmac_f32 v72, v9, v20
    v_fmac_f32 v76, v9, v24
    v_mfma_f32_16x16x32_bf16 v[50:53], v[164:167], v[26:29], v[50:53]
    v_fmac_f32 v73, v9, v21
    v_fmac_f32 v77, v9, v25
    v_mul_f32 v70, v70, v74
    s_waitcnt lgkmcnt(3)
    v_mfma_f32_16x16x32_bf16 v[54:57], v[160:163], v[30:33], v[54:57]
    ds_read_b128 v[26:29], v4 offset:9216
    v_mul_f32 v71, v71, v75
    v_mul_f32 v72, v72, v76
    v_mul_f32 v73, v73, v77
    v_mfma_f32_16x16x32_bf16 v[58:61], v[164:167], v[30:33], v[58:61]
    v_cvt_pk_bf16_f32 v68, v70, v71
    v_cvt_pk_bf16_f32 v69, v72, v73
    s_add_u32 s45, s42, 57344
    s_waitcnt lgkmcnt(3)
    v_mfma_f32_16x16x32_bf16 v[46:49], v[168:171], v[34:37], v[46:49]
    ds_read_b128 v[30:33], v4 offset:10240
    v_permlane32_swap_b32 v66, v68
    v_permlane32_swap_b32 v67, v69
    buffer_store_dwordx4 v[66:69], v7, s[32:35], s45 offen sc1
    v_mfma_f32_16x16x32_bf16 v[50:53], v[172:175], v[34:37], v[50:53]
    s_add_u32 m0, s58, 8192
    s_add_u32 s52, s51, 161792
    buffer_load_dwordx4 v11, s[24:27], s52 offen offset:3072 lds
    s_add_u32 m0, s63, 40960
    s_add_u32 s36, s50, s56
    buffer_load_dwordx4 v4, s[32:35], s36 offen sc1 lds
    s_add_u32 s56, s56, 4096
    s_sub_u32 s36, s56, 14336
    s_cselect_b32 s56, s56, s36
    s_waitcnt lgkmcnt(3)
    v_mfma_f32_16x16x32_bf16 v[54:57], v[168:171], v[38:41], v[54:57]
    ds_read_b128 v[34:37], v4 offset:11264
    s_add_u32 m0, s63, 49152
    s_add_u32 s36, s50, s56
    buffer_load_dwordx4 v4, s[32:35], s36 offen sc1 lds
    v_mfma_f32_16x16x32_bf16 v[58:61], v[172:175], v[38:41], v[58:61]
    s_waitcnt lgkmcnt(3)
    v_mfma_f32_16x16x32_bf16 v[46:49], v[176:179], v[42:45], v[46:49]
    ds_read_b128 v[38:41], v4 offset:12288
    v_mfma_f32_16x16x32_bf16 v[50:53], v[180:183], v[42:45], v[50:53]
    s_waitcnt lgkmcnt(3)
    v_mfma_f32_16x16x32_bf16 v[54:57], v[176:179], v[26:29], v[54:57]
    ds_read_b128 v[42:45], v4 offset:13312
    s_add_u32 m0, s58, 0
    s_add_u32 s52, s51, 172032
    buffer_load_dwordx4 v11, s[24:27], s52 offen offset:0 lds
    v_mfma_f32_16x16x32_bf16 v[58:61], v[180:183], v[26:29], v[58:61]
    s_waitcnt lgkmcnt(3)
    v_mfma_f32_16x16x32_bf16 v[46:49], v[184:187], v[30:33], v[46:49]
    ds_read_b128 v[26:29], v4 offset:14336
    v_mfma_f32_16x16x32_bf16 v[50:53], v[188:191], v[30:33], v[50:53]
    s_waitcnt lgkmcnt(3)
    v_mfma_f32_16x16x32_bf16 v[54:57], v[184:187], v[34:37], v[54:57]
    ds_read_b128 v[30:33], v4 offset:15360
    v_mfma_f32_16x16x32_bf16 v[58:61], v[188:191], v[34:37], v[58:61]
    s_waitcnt lgkmcnt(3)
    v_mfma_f32_16x16x32_bf16 v[46:49], v[192:195], v[38:41], v[46:49]
    ds_read_b128 v[34:37], v4 offset:16384
    s_add_u32 m0, s58, 0
    s_add_u32 s52, s51, 178176
    buffer_load_dwordx4 v11, s[24:27], s52 offen offset:1024 lds
    v_mfma_f32_16x16x32_bf16 v[50:53], v[196:199], v[38:41], v[50:53]
    s_waitcnt lgkmcnt(3)
    v_mfma_f32_16x16x32_bf16 v[54:57], v[192:195], v[42:45], v[54:57]
    ds_read_b128 v[38:41], v4 offset:17408
    v_mfma_f32_16x16x32_bf16 v[58:61], v[196:199], v[42:45], v[58:61]
    s_waitcnt lgkmcnt(3)
    v_mfma_f32_16x16x32_bf16 v[46:49], v[200:203], v[26:29], v[46:49]
    ds_read_b128 v[42:45], v4 offset:18432
    v_mfma_f32_16x16x32_bf16 v[50:53], v[204:207], v[26:29], v[50:53]
    s_waitcnt lgkmcnt(3)
    v_mfma_f32_16x16x32_bf16 v[54:57], v[200:203], v[30:33], v[54:57]
    ds_read_b128 v[26:29], v4 offset:19456
    s_add_u32 m0, s58, 0
    s_add_u32 s52, s51, 184320
    buffer_load_dwordx4 v11, s[24:27], s52 offen offset:2048 lds
    v_mfma_f32_16x16x32_bf16 v[58:61], v[204:207], v[30:33], v[58:61]
    s_waitcnt lgkmcnt(3)
    v_mfma_f32_16x16x32_bf16 v[46:49], v[208:211], v[34:37], v[46:49]
    ds_read_b128 v[30:33], v4 offset:20480
    v_mfma_f32_16x16x32_bf16 v[50:53], v[212:215], v[34:37], v[50:53]
    s_waitcnt lgkmcnt(3)
    v_mfma_f32_16x16x32_bf16 v[54:57], v[208:211], v[38:41], v[54:57]
    ds_read_b128 v[34:37], v4 offset:21504
    v_mfma_f32_16x16x32_bf16 v[58:61], v[212:215], v[38:41], v[58:61]
    s_waitcnt lgkmcnt(3)
    v_mfma_f32_16x16x32_bf16 v[46:49], v[216:219], v[42:45], v[46:49]
    ds_read_b128 v[38:41], v4 offset:22528
    s_add_u32 m0, s58, 0
    s_add_u32 s52, s51, 190464
    buffer_load_dwordx4 v11, s[24:27], s52 offen offset:3072 lds
    v_mfma_f32_16x16x32_bf16 v[50:53], v[220:223], v[42:45], v[50:53]
    s_waitcnt lgkmcnt(3)
    v_mfma_f32_16x16x32_bf16 v[54:57], v[216:219], v[26:29], v[54:57]
    ds_read_b128 v[42:45], v4 offset:23552
    v_mfma_f32_16x16x32_bf16 v[58:61], v[220:223], v[26:29], v[58:61]
    s_waitcnt vmcnt(12) lgkmcnt(3)
    s_barrier
    v_mfma_f32_16x16x32_bf16 v[46:49], v[224:227], v[30:33], v[46:49]
    ds_read_b128 v[26:29], v4 offset:24576
    v_mfma_f32_16x16x32_bf16 v[50:53], v[228:231], v[30:33], v[50:53]
    s_waitcnt lgkmcnt(3)
    v_mfma_f32_16x16x32_bf16 v[54:57], v[224:227], v[34:37], v[54:57]
    ds_read_b128 v[30:33], v4 offset:25600
    s_mov_b64 exec, 0x00003fff
    buffer_load_dword v0, v10, s[32:35], s44 offen offset:4 sc1
    s_mov_b64 exec, -1
    v_mfma_f32_16x16x32_bf16 v[58:61], v[228:231], v[34:37], v[58:61]
    s_waitcnt lgkmcnt(3)
    v_mfma_f32_16x16x32_bf16 v[46:49], v[232:235], v[38:41], v[46:49]
    ds_read_b128 v[34:37], v4 offset:26624
    s_waitcnt vmcnt(8)
    s_mov_b64 exec, 0xff
    buffer_store_dwordx4 v[4:7], v4, s[32:35], s54 offen offset:0 sc1
    s_mov_b64 exec, -1
    s_add_u32 s54, s54, 14336
    v_mfma_f32_16x16x32_bf16 v[50:53], v[236:239], v[38:41], v[50:53]
    s_waitcnt lgkmcnt(3)
    v_mfma_f32_16x16x32_bf16 v[54:57], v[232:235], v[42:45], v[54:57]
    ds_read_b128 v[38:41], v4 offset:27648
    v_mfma_f32_16x16x32_bf16 v[58:61], v[236:239], v[42:45], v[58:61]
    s_waitcnt lgkmcnt(3)
    v_mfma_f32_16x16x32_bf16 v[46:49], v[240:243], v[26:29], v[46:49]
    ds_read_b128 v[42:45], v4 offset:28672
    v_mfma_f32_16x16x32_bf16 v[50:53], v[244:247], v[26:29], v[50:53]
    s_waitcnt lgkmcnt(3)
    v_mfma_f32_16x16x32_bf16 v[54:57], v[240:243], v[30:33], v[54:57]
    ds_read_b128 v[26:29], v4 offset:29696
    v_mfma_f32_16x16x32_bf16 v[58:61], v[244:247], v[30:33], v[58:61]
    s_waitcnt lgkmcnt(3)
    v_mfma_f32_16x16x32_bf16 v[46:49], v[248:251], v[34:37], v[46:49]
    ds_read_b128 v[30:33], v4 offset:30720
    ds_read2_b32 v[8:9], v12 offset0:64 offset1:192
    v_mfma_f32_16x16x32_bf16 v[50:53], v[252:255], v[34:37], v[50:53]
    s_waitcnt lgkmcnt(4)
    v_mfma_f32_16x16x32_bf16 v[54:57], v[248:251], v[38:41], v[54:57]
    ds_read_b128 v[34:37], v4 offset:31744
    v_mfma_f32_16x16x32_bf16 v[58:61], v[252:255], v[38:41], v[58:61]
    s_waitcnt lgkmcnt(4)
    v_mfma_f32_16x16x32_bf16 v[62:65], v[144:147], v[42:45], 0
    ds_read_b128 v[38:41], v4 offset:32768
    v_mfma_f32_16x16x32_bf16 v[66:69], v[148:151], v[42:45], 0
    s_waitcnt lgkmcnt(4)
    v_mfma_f32_16x16x32_bf16 v[70:73], v[144:147], v[26:29], 0
    ds_read_b128 v[42:45], v4 offset:33792
    s_waitcnt lgkmcnt(3)
    v_fmac_f32 v46, v8, v18
    v_fmac_f32 v50, v8, v22
    v_mfma_f32_16x16x32_bf16 v[74:77], v[148:151], v[26:29], 0
    v_fmac_f32 v47, v8, v19
    v_fmac_f32 v51, v8, v23
    v_fmac_f32 v48, v8, v20
    v_mfma_f32_16x16x32_bf16 v[62:65], v[152:155], v[30:33], v[62:65]
    ds_read_b128 v[26:29], v4 offset:34816
    v_fmac_f32 v52, v8, v24
    v_fmac_f32 v49, v8, v21
    v_fmac_f32 v53, v8, v25
    v_mfma_f32_16x16x32_bf16 v[66:69], v[156:159], v[30:33], v[66:69]
    v_mul_f32 v46, v46, v50
    v_mul_f32 v47, v47, v51
    v_mul_f32 v48, v48, v52
    s_waitcnt lgkmcnt(3)
    v_mfma_f32_16x16x32_bf16 v[70:73], v[152:155], v[34:37], v[70:73]
    ds_read_b128 v[30:33], v4 offset:35840
    v_mul_f32 v49, v49, v53
    v_cvt_pk_bf16_f32 v50, v46, v47
    v_cvt_pk_bf16_f32 v51, v48, v49
    v_mfma_f32_16x16x32_bf16 v[74:77], v[156:159], v[34:37], v[74:77]
    v_fmac_f32 v54, v9, v18
    v_fmac_f32 v58, v9, v22
    v_fmac_f32 v55, v9, v19
    s_waitcnt lgkmcnt(3)
    v_mfma_f32_16x16x32_bf16 v[62:65], v[160:163], v[38:41], v[62:65]
    ds_read_b128 v[34:37], v4 offset:36864
    v_fmac_f32 v59, v9, v23
    v_fmac_f32 v56, v9, v20
    v_fmac_f32 v60, v9, v24
    v_mfma_f32_16x16x32_bf16 v[66:69], v[164:167], v[38:41], v[66:69]
    v_fmac_f32 v57, v9, v21
    v_fmac_f32 v61, v9, v25
    v_mul_f32 v54, v54, v58
    s_waitcnt lgkmcnt(3)
    v_mfma_f32_16x16x32_bf16 v[70:73], v[160:163], v[42:45], v[70:73]
    ds_read_b128 v[38:41], v4 offset:37888
    v_mul_f32 v55, v55, v59
    v_mul_f32 v56, v56, v60
    v_mul_f32 v57, v57, v61
    v_mfma_f32_16x16x32_bf16 v[74:77], v[164:167], v[42:45], v[74:77]
    v_cvt_pk_bf16_f32 v52, v54, v55
    v_cvt_pk_bf16_f32 v53, v56, v57
    s_add_u32 s45, s42, 114688
    s_waitcnt lgkmcnt(3)
    v_mfma_f32_16x16x32_bf16 v[62:65], v[168:171], v[26:29], v[62:65]
    ds_read_b128 v[42:45], v4 offset:38912
    v_permlane32_swap_b32 v50, v52
    v_permlane32_swap_b32 v51, v53
    buffer_store_dwordx4 v[50:53], v7, s[32:35], s45 offen sc1
    v_mfma_f32_16x16x32_bf16 v[66:69], v[172:175], v[26:29], v[66:69]
    s_waitcnt vmcnt(2)
    s_mov_b64 exec, 0x00003fff
.Lpw_47:
    v_cmp_ne_u32 vcc, v0, v5
    s_and_b64 exec, exec, vcc
    s_cbranch_scc0 .Lpd_48
    buffer_load_dword v0, v10, s[32:35], s44 offen offset:4 sc1
    s_sub_u32 s48, s48, 1
    s_waitcnt vmcnt(0)
    s_cbranch_scc0 .Lpw_47
    s_mov_b32 s48, 0
.Lpd_48:
    s_mov_b64 exec, -1
    s_waitcnt lgkmcnt(3)
    v_mfma_f32_16x16x32_bf16 v[70:73], v[168:171], v[30:33], v[70:73]
    ds_read_b128 v[26:29], v4 offset:39936
    s_add_u32 s38, s47, 0
    s_add_u32 s39, s47, 4096
    buffer_load_dwordx4 v[144:147], v4, s[32:35], s38 offen offset:0 sc1
    v_mfma_f32_16x16x32_bf16 v[74:77], v[172:175], v[30:33], v[74:77]
    buffer_load_dwordx4 v[148:151], v4, s[32:35], s38 offen offset:1024 sc1
    buffer_load_dwordx4 v[152:155], v4, s[32:35], s38 offen offset:2048 sc1
    s_waitcnt lgkmcnt(3)
    s_barrier
    v_mfma_f32_16x16x32_bf16 v[62:65], v[176:179], v[34:37], v[62:65]
    ds_read_b128 v[30:33], v4 offset:40960
    buffer_load_dwordx4 v[156:159], v4, s[32:35], s38 offen offset:3072 sc1
    v_mfma_f32_16x16x32_bf16 v[66:69], v[180:183], v[34:37], v[66:69]
    s_waitcnt lgkmcnt(3)
    v_mfma_f32_16x16x32_bf16 v[70:73], v[176:179], v[38:41], v[70:73]
    ds_read_b128 v[34:37], v4 offset:41984
    buffer_load_dwordx4 v[160:163], v4, s[32:35], s39 offen offset:0 sc1
    v_mfma_f32_16x16x32_bf16 v[74:77], v[180:183], v[38:41], v[74:77]
    s_waitcnt lgkmcnt(3)
    v_mfma_f32_16x16x32_bf16 v[62:65], v[184:187], v[42:45], v[62:65]
    ds_read_b128 v[38:41], v4 offset:43008
    v_mfma_f32_16x16x32_bf16 v[66:69], v[188:191], v[42:45], v[66:69]
    s_waitcnt lgkmcnt(3)
    v_mfma_f32_16x16x32_bf16 v[70:73], v[184:187], v[26:29], v[70:73]
    ds_read_b128 v[42:45], v4 offset:44032
    buffer_load_dwordx4 v[164:167], v4, s[32:35], s39 offen offset:1024 sc1
    v_mfma_f32_16x16x32_bf16 v[74:77], v[188:191], v[26:29], v[74:77]
    s_waitcnt lgkmcnt(3)
    v_mfma_f32_16x16x32_bf16 v[62:65], v[192:195], v[30:33], v[62:65]
    ds_read_b128 v[26:29], v4 offset:45056
    v_mfma_f32_16x16x32_bf16 v[66:69], v[196:199], v[30:33], v[66:69]
    s_waitcnt lgkmcnt(3)
    v_mfma_f32_16x16x32_bf16 v[70:73], v[192:195], v[34:37], v[70:73]
    ds_read_b128 v[30:33], v4 offset:46080
    buffer_load_dwordx4 v[168:171], v4, s[32:35], s39 offen offset:2048 sc1
    v_mfma_f32_16x16x32_bf16 v[74:77], v[196:199], v[34:37], v[74:77]
    s_waitcnt lgkmcnt(3)
    v_mfma_f32_16x16x32_bf16 v[62:65], v[200:203], v[38:41], v[62:65]
    ds_read_b128 v[34:37], v4 offset:47104
    v_mfma_f32_16x16x32_bf16 v[66:69], v[204:207], v[38:41], v[66:69]
    ds_read_b64_tr_b16 v[46:47], v14 offset:4096
    s_waitcnt lgkmcnt(4)
    v_mfma_f32_16x16x32_bf16 v[70:73], v[200:203], v[42:45], v[70:73]
    ds_read_b128 v[38:41], v4 offset:48128
    ds_read_b64_tr_b16 v[48:49], v14 offset:5120
    v_mfma_f32_16x16x32_bf16 v[74:77], v[204:207], v[42:45], v[74:77]
    ds_read_b64_tr_b16 v[50:51], v15 offset:4096
    s_waitcnt lgkmcnt(6)
    v_mfma_f32_16x16x32_bf16 v[62:65], v[208:211], v[26:29], v[62:65]
    ds_read_b128 v[42:45], v4 offset:49152
    ds_read_b64_tr_b16 v[52:53], v15 offset:5120
    v_mfma_f32_16x16x32_bf16 v[66:69], v[212:215], v[26:29], v[66:69]
    ds_read_b64_tr_b16 v[54:55], v16 offset:4096
    s_waitcnt lgkmcnt(8)
    v_mfma_f32_16x16x32_bf16 v[70:73], v[208:211], v[30:33], v[70:73]
    ds_read_b128 v[26:29], v4 offset:50176
    ds_read_b64_tr_b16 v[56:57], v16 offset:5120
    v_mfma_f32_16x16x32_bf16 v[74:77], v[212:215], v[30:33], v[74:77]
    ds_read_b64_tr_b16 v[58:59], v17 offset:4096
    s_waitcnt lgkmcnt(10)
    v_mfma_f32_16x16x32_bf16 v[62:65], v[216:219], v[34:37], v[62:65]
    ds_read_b128 v[30:33], v4 offset:51200
    ds_read_b64_tr_b16 v[60:61], v17 offset:5120
    v_mfma_f32_16x16x32_bf16 v[66:69], v[220:223], v[34:37], v[66:69]
    s_add_u32 s44, s44, 14336
    s_mov_b64 exec, 0x00003fff
    buffer_load_dword v0, v10, s[32:35], s44 offen offset:4 sc1
    s_mov_b64 exec, -1
    s_waitcnt vmcnt(8)
    s_mov_b64 exec, 0xff
    buffer_store_dwordx4 v[4:7], v4, s[32:35], s54 offen offset:0 sc1
    s_mov_b64 exec, -1
    s_add_u32 s54, s54, 14336
    s_waitcnt lgkmcnt(10)
    v_mfma_f32_16x16x32_bf16 v[70:73], v[216:219], v[38:41], v[70:73]
    ds_read_b128 v[34:37], v4 offset:52224
    v_mfma_f32_16x16x32_bf16 v[74:77], v[220:223], v[38:41], v[74:77]
    s_waitcnt lgkmcnt(8)
    v_mfma_f32_16x16x32_bf16 v[62:65], v[224:227], v[42:45], v[62:65]
    ds_read_b128 v[38:41], v4 offset:53248
    v_mfma_f32_16x16x32_bf16 v[66:69], v[228:231], v[42:45], v[66:69]
    s_waitcnt lgkmcnt(6)
    v_mfma_f32_16x16x32_bf16 v[70:73], v[224:227], v[26:29], v[70:73]
    ds_read_b128 v[42:45], v4 offset:54272
    s_waitcnt vmcnt(1)
    s_mov_b64 exec, 0x00003fff
.Lpw_50:
    v_cmp_ne_u32 vcc, v0, v5
    s_and_b64 exec, exec, vcc
    s_cbranch_scc0 .Lpd_51
    buffer_load_dword v0, v10, s[32:35], s44 offen offset:4 sc1
    s_sub_u32 s48, s48, 1
    s_waitcnt vmcnt(0)
    s_cbranch_scc0 .Lpw_50
    s_mov_b32 s48, 0
.Lpd_51:
    s_mov_b64 exec, -1
    v_mfma_f32_16x16x32_bf16 v[74:77], v[228:231], v[26:29], v[74:77]
    s_add_u32 s38, s47, 57344
    s_add_u32 s39, s47, 61440
    buffer_load_dwordx4 v[172:175], v4, s[32:35], s38 offen offset:0 sc1
    s_waitcnt lgkmcnt(4)
    v_mfma_f32_16x16x32_bf16 v[62:65], v[232:235], v[30:33], v[62:65]
    ds_read_b128 v[26:29], v4 offset:55296
    buffer_load_dwordx4 v[176:179], v4, s[32:35], s38 offen offset:1024 sc1
    v_mfma_f32_16x16x32_bf16 v[66:69], v[236:239], v[30:33], v[66:69]
    s_waitcnt lgkmcnt(3)
    v_mfma_f32_16x16x32_bf16 v[70:73], v[232:235], v[34:37], v[70:73]
    ds_read_b128 v[30:33], v4 offset:56320
    buffer_load_dwordx4 v[180:183], v4, s[32:35], s38 offen offset:2048 sc1
    v_mfma_f32_16x16x32_bf16 v[74:77], v[236:239], v[34:37], v[74:77]
    s_waitcnt lgkmcnt(3)
    v_mfma_f32_16x16x32_bf16 v[62:65], v[240:243], v[38:41], v[62:65]
    buffer_load_dwordx4 v[184:187], v4, s[32:35], s38 offen offset:3072 sc1
    v_mfma_f32_16x16x32_bf16 v[66:69], v[244:247], v[38:41], v[66:69]
    s_waitcnt lgkmcnt(2)
    v_mfma_f32_16x16x32_bf16 v[70:73], v[240:243], v[42:45], v[70:73]
    buffer_load_dwordx4 v[188:191], v4, s[32:35], s39 offen offset:0 sc1
    v_mfma_f32_16x16x32_bf16 v[74:77], v[244:247], v[42:45], v[74:77]
    s_waitcnt lgkmcnt(1)
    v_mfma_f32_16x16x32_bf16 v[62:65], v[248:251], v[26:29], v[62:65]
    ds_read2_b32 v[8:9], v12 offset0:96 offset1:224
    buffer_load_dwordx4 v[192:195], v4, s[32:35], s39 offen offset:1024 sc1
    v_mfma_f32_16x16x32_bf16 v[66:69], v[252:255], v[26:29], v[66:69]
    s_waitcnt lgkmcnt(1)
    v_mfma_f32_16x16x32_bf16 v[70:73], v[248:251], v[30:33], v[70:73]
    buffer_load_dwordx4 v[196:199], v4, s[32:35], s39 offen offset:2048 sc1
    v_mfma_f32_16x16x32_bf16 v[74:77], v[252:255], v[30:33], v[74:77]
    s_add_u32 s44, s44, 14336
    s_mov_b64 exec, 0x00003fff
    buffer_load_dword v0, v10, s[32:35], s44 offen offset:4 sc1
    s_mov_b64 exec, -1
    ds_read_b64_tr_b16 v[228:229], v14 offset:8192
    ds_read_b64_tr_b16 v[230:231], v14 offset:9216
    ds_read_b64_tr_b16 v[232:233], v15 offset:8192
    ds_read_b64_tr_b16 v[234:235], v15 offset:9216
    ds_read_b64_tr_b16 v[236:237], v16 offset:8192
    ds_read_b64_tr_b16 v[238:239], v16 offset:9216
    ds_read_b64_tr_b16 v[240:241], v17 offset:8192
    ds_read_b64_tr_b16 v[242:243], v17 offset:9216
    ds_read_b64_tr_b16 v[26:27], v14 offset:0
    ds_read_b64_tr_b16 v[28:29], v14 offset:1024
    ds_read_b64_tr_b16 v[30:31], v15 offset:0
    ds_read_b64_tr_b16 v[32:33], v15 offset:1024
    ds_read_b64_tr_b16 v[34:35], v16 offset:0
    ds_read_b64_tr_b16 v[36:37], v16 offset:1024
    ds_read_b64_tr_b16 v[38:39], v17 offset:0
    ds_read_b64_tr_b16 v[40:41], v17 offset:1024
    s_waitcnt lgkmcnt(15)
    v_fmac_f32 v62, v8, v18
    v_fmac_f32 v66, v8, v22
    v_fmac_f32 v63, v8, v19
    v_fmac_f32 v67, v8, v23
    v_fmac_f32 v64, v8, v20
    v_fmac_f32 v68, v8, v24
    v_fmac_f32 v65, v8, v21
    v_fmac_f32 v69, v8, v25
    v_mul_f32 v62, v62, v66
    v_mul_f32 v63, v63, v67
    v_mul_f32 v64, v64, v68
    v_mul_f32 v65, v65, v69
    v_cvt_pk_bf16_f32 v66, v62, v63
    v_cvt_pk_bf16_f32 v67, v64, v65
    v_fmac_f32 v70, v9, v18
    v_fmac_f32 v74, v9, v22
    v_fmac_f32 v71, v9, v19
    v_fmac_f32 v75, v9, v23
    v_fmac_f32 v72, v9, v20
    v_fmac_f32 v76, v9, v24
    v_fmac_f32 v73, v9, v21
    v_fmac_f32 v77, v9, v25
    v_mul_f32 v70, v70, v74
    v_mul_f32 v71, v71, v75
    v_mul_f32 v72, v72, v76
    v_mul_f32 v73, v73, v77
    v_cvt_pk_bf16_f32 v68, v70, v71
    v_cvt_pk_bf16_f32 v69, v72, v73
    s_add_u32 s45, s42, 172032
    v_permlane32_swap_b32 v66, v68
    v_permlane32_swap_b32 v67, v69
    buffer_store_dwordx4 v[66:69], v7, s[32:35], s45 offen sc1
    v_mfma_f32_16x16x32_bf16 v[62:65], v[78:81], v[144:147], 0
    v_add_u32 v244, s58, v4
    s_and_b32 s36, s3, 3
    v_mfma_f32_16x16x32_bf16 v[66:69], v[82:85], v[144:147], 0
    s_lshl3_add_u32 s36, s62, s36
    s_lshl_b32 s36, s36, 10
    v_mfma_f32_16x16x32_bf16 v[70:73], v[86:89], v[144:147], 0
    s_add_u32 s36, s36, 57344
    v_add_u32 v245, s36, v4
    v_mfma_f32_16x16x32_bf16 v[74:77], v[90:93], v[144:147], 0
    v_add_u32 v246, 49152, v245
    s_lshl1_add_u32 s36, s40, s62
    v_mfma_f32_16x16x32_bf16 v[62:65], v[94:97], v[148:151], v[62:65]
    s_lshl_b32 s36, s36, 8
    v_add_u32 v143, s36, v12
    v_mfma_f32_16x16x32_bf16 v[66:69], v[98:101], v[148:151], v[66:69]
    ds_read2_b32 v[248:249], v143 offset0:1 offset1:33
    v_bfe_u32 v247, v4, 4, 4
    v_mfma_f32_16x16x32_bf16 v[70:73], v[102:105], v[148:151], v[70:73]
    v_mul_u32_u24 v247, 896, v247
    v_lshrrev_b32 v143, 8, v4
    v_mfma_f32_16x16x32_bf16 v[74:77], v[106:109], v[148:151], v[74:77]
    v_lshl_add_u32 v247, v143, 3, v247
    v_mfma_f32_16x16x32_bf16 v[62:65], v[110:113], v[152:155], v[62:65]
    s_waitcnt vmcnt(0)
    s_mov_b64 exec, 0xff
    buffer_store_dwordx4 v[4:7], v4, s[32:35], s54 offen offset:0 sc1
    s_mov_b64 exec, -1
    v_mfma_f32_16x16x32_bf16 v[66:69], v[114:117], v[152:155], v[66:69]
    v_mfma_f32_16x16x32_bf16 v[70:73], v[118:121], v[152:155], v[70:73]
    v_mfma_f32_16x16x32_bf16 v[74:77], v[122:125], v[152:155], v[74:77]
    v_mfma_f32_16x16x32_bf16 v[62:65], v[126:129], v[156:159], v[62:65]
    v_mfma_f32_16x16x32_bf16 v[66:69], v[130:133], v[156:159], v[66:69]
    s_mov_b64 exec, 0x00003fff
.Lpw_53:
    v_cmp_ne_u32 vcc, v0, v5
    s_and_b64 exec, exec, vcc
    s_cbranch_scc0 .Lpd_54
    buffer_load_dword v0, v10, s[32:35], s44 offen offset:4 sc1
    s_sub_u32 s48, s48, 1
    s_waitcnt vmcnt(0)
    s_cbranch_scc0 .Lpw_53
    s_mov_b32 s48, 0
.Lpd_54:
    s_mov_b64 exec, -1
    v_mfma_f32_16x16x32_bf16 v[70:73], v[134:137], v[156:159], v[70:73]
    s_add_u32 s38, s47, 114688
    s_add_u32 s39, s47, 118784
    v_mfma_f32_16x16x32_bf16 v[74:77], v[138:141], v[156:159], v[74:77]
    buffer_load_dwordx4 v[200:203], v4, s[32:35], s38 offen offset:0 sc1
    v_mfma_f32_16x16x32_bf16 v[62:65], v[46:49], v[160:163], v[62:65]
    buffer_load_dwordx4 v[204:207], v4, s[32:35], s38 offen offset:1024 sc1
    v_mfma_f32_16x16x32_bf16 v[66:69], v[50:53], v[160:163], v[66:69]
    buffer_load_dwordx4 v[208:211], v4, s[32:35], s38 offen offset:2048 sc1
    v_mfma_f32_16x16x32_bf16 v[70:73], v[54:57], v[160:163], v[70:73]
    buffer_load_dwordx4 v[212:215], v4, s[32:35], s38 offen offset:3072 sc1
    v_mfma_f32_16x16x32_bf16 v[74:77], v[58:61], v[160:163], v[74:77]
    buffer_load_dwordx4 v[216:219], v4, s[32:35], s39 offen offset:0 sc1
    s_waitcnt lgkmcnt(9)
    v_mfma_f32_16x16x32_bf16 v[62:65], v[228:231], v[164:167], v[62:65]
    buffer_load_dwordx4 v[220:223], v4, s[32:35], s39 offen offset:1024 sc1
    v_mfma_f32_16x16x32_bf16 v[66:69], v[232:235], v[164:167], v[66:69]
    buffer_load_dwordx4 v[224:227], v4, s[32:35], s39 offen offset:2048 sc1
    v_mfma_f32_16x16x32_bf16 v[70:73], v[236:239], v[164:167], v[70:73]
    v_mfma_f32_16x16x32_bf16 v[74:77], v[240:243], v[164:167], v[74:77]
    s_waitcnt lgkmcnt(1)
    v_mfma_f32_16x16x32_bf16 v[62:65], v[26:29], v[168:171], v[62:65]
    v_mfma_f32_16x16x32_bf16 v[66:69], v[30:33], v[168:171], v[66:69]
    v_mfma_f32_16x16x32_bf16 v[70:73], v[34:37], v[168:171], v[70:73]
    v_mfma_f32_16x16x32_bf16 v[74:77], v[38:41], v[168:171], v[74:77]
    v_mfma_f32_16x16x32_bf16 v[144:147], v[78:81], v[172:175], 0
    v_mfma_f32_16x16x32_bf16 v[148:151], v[82:85], v[172:175], 0
    v_mfma_f32_16x16x32_bf16 v[152:155], v[86:89], v[172:175], 0
    v_mfma_f32_16x16x32_bf16 v[156:159], v[90:93], v[172:175], 0
    v_mfma_f32_16x16x32_bf16 v[144:147], v[94:97], v[176:179], v[144:147]
    v_mfma_f32_16x16x32_bf16 v[148:151], v[98:101], v[176:179], v[148:151]
    v_mfma_f32_16x16x32_bf16 v[152:155], v[102:105], v[176:179], v[152:155]
    v_mfma_f32_16x16x32_bf16 v[156:159], v[106:109], v[176:179], v[156:159]
    v_mfma_f32_16x16x32_bf16 v[144:147], v[110:113], v[180:183], v[144:147]
    ds_write_b128 v244, v[62:65] offset:0
    v_mfma_f32_16x16x32_bf16 v[148:151], v[114:117], v[180:183], v[148:151]
    ds_write_b128 v244, v[66:69] offset:1024
    v_mfma_f32_16x16x32_bf16 v[152:155], v[118:121], v[180:183], v[152:155]
    ds_write_b128 v244, v[70:73] offset:2048
    v_mfma_f32_16x16x32_bf16 v[156:159], v[122:125], v[180:183], v[156:159]
    ds_write_b128 v244, v[74:77] offset:3072
    v_mfma_f32_16x16x32_bf16 v[144:147], v[126:129], v[184:187], v[144:147]
    v_mfma_f32_16x16x32_bf16 v[148:151], v[130:133], v[184:187], v[148:151]
    v_mfma_f32_16x16x32_bf16 v[152:155], v[134:137], v[184:187], v[152:155]
    v_mfma_f32_16x16x32_bf16 v[156:159], v[138:141], v[184:187], v[156:159]
    v_mfma_f32_16x16x32_bf16 v[144:147], v[46:49], v[188:191], v[144:147]
    v_mfma_f32_16x16x32_bf16 v[148:151], v[50:53], v[188:191], v[148:151]
    v_mfma_f32_16x16x32_bf16 v[152:155], v[54:57], v[188:191], v[152:155]
    v_mfma_f32_16x16x32_bf16 v[156:159], v[58:61], v[188:191], v[156:159]
    v_mfma_f32_16x16x32_bf16 v[144:147], v[228:231], v[192:195], v[144:147]
    v_mfma_f32_16x16x32_bf16 v[148:151], v[232:235], v[192:195], v[148:151]
    v_mfma_f32_16x16x32_bf16 v[152:155], v[236:239], v[192:195], v[152:155]
    v_mfma_f32_16x16x32_bf16 v[156:159], v[240:243], v[192:195], v[156:159]
    v_mfma_f32_16x16x32_bf16 v[144:147], v[26:29], v[196:199], v[144:147]
    v_mfma_f32_16x16x32_bf16 v[148:151], v[30:33], v[196:199], v[148:151]
    v_mfma_f32_16x16x32_bf16 v[152:155], v[34:37], v[196:199], v[152:155]
    v_mfma_f32_16x16x32_bf16 v[156:159], v[38:41], v[196:199], v[156:159]
    s_waitcnt vmcnt(6)
    v_mfma_f32_16x16x32_bf16 v[62:65], v[78:81], v[200:203], 0
    v_mfma_f32_16x16x32_bf16 v[66:69], v[82:85], v[200:203], 0
    v_mfma_f32_16x16x32_bf16 v[70:73], v[86:89], v[200:203], 0
    v_mfma_f32_16x16x32_bf16 v[74:77], v[90:93], v[200:203], 0
    s_waitcnt vmcnt(5)
    v_mfma_f32_16x16x32_bf16 v[62:65], v[94:97], v[204:207], v[62:65]
    v_mfma_f32_16x16x32_bf16 v[66:69], v[98:101], v[204:207], v[66:69]
    v_mfma_f32_16x16x32_bf16 v[70:73], v[102:105], v[204:207], v[70:73]
    v_mfma_f32_16x16x32_bf16 v[74:77], v[106:109], v[204:207], v[74:77]
    s_waitcnt vmcnt(4)
    v_mfma_f32_16x16x32_bf16 v[62:65], v[110:113], v[208:211], v[62:65]
    ds_write_b128 v244, v[144:147] offset:4096
    v_mfma_f32_16x16x32_bf16 v[66:69], v[114:117], v[208:211], v[66:69]
    ds_write_b128 v244, v[148:151] offset:5120
    v_mfma_f32_16x16x32_bf16 v[70:73], v[118:121], v[208:211], v[70:73]
    ds_write_b128 v244, v[152:155] offset:6144
    v_mfma_f32_16x16x32_bf16 v[74:77], v[122:125], v[208:211], v[74:77]
    ds_write_b128 v244, v[156:159] offset:7168
    s_waitcnt vmcnt(3)
    v_mfma_f32_16x16x32_bf16 v[62:65], v[126:129], v[212:215], v[62:65]
    v_mfma_f32_16x16x32_bf16 v[66:69], v[130:133], v[212:215], v[66:69]
    v_mfma_f32_16x16x32_bf16 v[70:73], v[134:137], v[212:215], v[70:73]
    v_mfma_f32_16x16x32_bf16 v[74:77], v[138:141], v[212:215], v[74:77]
    s_waitcnt vmcnt(2)
    v_mfma_f32_16x16x32_bf16 v[62:65], v[46:49], v[216:219], v[62:65]
    v_mfma_f32_16x16x32_bf16 v[66:69], v[50:53], v[216:219], v[66:69]
    v_mfma_f32_16x16x32_bf16 v[70:73], v[54:57], v[216:219], v[70:73]
    v_mfma_f32_16x16x32_bf16 v[74:77], v[58:61], v[216:219], v[74:77]
    s_waitcnt vmcnt(1)
    v_mfma_f32_16x16x32_bf16 v[62:65], v[228:231], v[220:223], v[62:65]
    v_mfma_f32_16x16x32_bf16 v[66:69], v[232:235], v[220:223], v[66:69]
    v_mfma_f32_16x16x32_bf16 v[70:73], v[236:239], v[220:223], v[70:73]
    v_mfma_f32_16x16x32_bf16 v[74:77], v[240:243], v[220:223], v[74:77]
    s_waitcnt vmcnt(0)
    v_mfma_f32_16x16x32_bf16 v[62:65], v[26:29], v[224:227], v[62:65]
    s_add_u32 s44, s44, 14336
    s_mov_b64 exec, 0x00003fff
    buffer_load_dword v0, v10, s[32:35], s44 offen offset:4 sc1
    s_mov_b64 exec, -1
    v_mfma_f32_16x16x32_bf16 v[66:69], v[30:33], v[224:227], v[66:69]
    v_mfma_f32_16x16x32_bf16 v[70:73], v[34:37], v[224:227], v[70:73]
    v_mfma_f32_16x16x32_bf16 v[74:77], v[38:41], v[224:227], v[74:77]
    s_nop 0
    ds_write_b128 v244, v[62:65] offset:8192
    s_nop 3
    ds_write_b128 v244, v[66:69] offset:9216
    ds_write_b128 v244, v[70:73] offset:10240
    ds_write_b128 v244, v[74:77] offset:11264
    s_waitcnt vmcnt(0)
    s_mov_b64 exec, 0x00003fff
.Lpw_55:
    v_cmp_ne_u32 vcc, v0, v5
    s_and_b64 exec, exec, vcc
    s_cbranch_scc0 .Lpd_56
    buffer_load_dword v0, v10, s[32:35], s44 offen offset:4 sc1
    s_sub_u32 s48, s48, 1
    s_waitcnt vmcnt(0)
    s_cbranch_scc0 .Lpw_55
    s_mov_b32 s48, 0
.Lpd_56:
    s_mov_b64 exec, -1
    s_add_u32 s38, s47, 172032
    s_add_u32 s39, s47, 176128
    buffer_load_dwordx4 v[172:175], v4, s[32:35], s38 offen offset:0 sc1
    buffer_load_dwordx4 v[176:179], v4, s[32:35], s38 offen offset:1024 sc1
    buffer_load_dwordx4 v[180:183], v4, s[32:35], s38 offen offset:2048 sc1
    buffer_load_dwordx4 v[184:187], v4, s[32:35], s38 offen offset:3072 sc1
    buffer_load_dwordx4 v[188:191], v4, s[32:35], s39 offen offset:0 sc1
    buffer_load_dwordx4 v[192:195], v4, s[32:35], s39 offen offset:1024 sc1
    buffer_load_dwordx4 v[196:199], v4, s[32:35], s39 offen offset:2048 sc1
    s_waitcnt lgkmcnt(0)
    s_barrier
    ds_read_b128 v[200:203], v245 offset:0
    ds_read_b128 v[204:207], v245 offset:12288
    ds_read_b128 v[208:211], v245 offset:24576
    ds_read_b128 v[212:215], v245 offset:36864
    ds_read_b128 v[216:219], v246 offset:0
    ds_read_b128 v[220:223], v246 offset:12288
    ds_read_b128 v[224:227], v246 offset:24576
    ds_read_b128 v[160:163], v246 offset:36864
    v_lshlrev_b32 v250, 16, v1
    v_and_b32 v251, 0xffff0000, v1
    v_lshlrev_b32 v252, 16, v2
    v_and_b32 v253, 0xffff0000, v2
    s_waitcnt lgkmcnt(6)
    v_pk_add_f32 v[200:201], v[200:201], v[204:205]
    v_pk_add_f32 v[202:203], v[202:203], v[206:207]
    s_waitcnt lgkmcnt(4)
    v_pk_add_f32 v[208:209], v[208:209], v[212:213]
    v_pk_add_f32 v[210:211], v[210:211], v[214:215]
    v_pk_add_f32 v[200:201], v[200:201], v[208:209]
    v_pk_add_f32 v[202:203], v[202:203], v[210:211]
    s_waitcnt lgkmcnt(2)
    v_pk_add_f32 v[216:217], v[216:217], v[220:221]
    v_pk_add_f32 v[218:219], v[218:219], v[222:223]
    s_waitcnt lgkmcnt(0)
    v_pk_add_f32 v[224:225], v[224:225], v[160:161]
    v_pk_add_f32 v[226:227], v[226:227], v[162:163]
    v_pk_add_f32 v[216:217], v[216:217], v[224:225]
    v_pk_add_f32 v[218:219], v[218:219], v[226:227]
    v_pk_add_f32 v[200:201], v[200:201], v[216:217]
    v_pk_add_f32 v[202:203], v[202:203], v[218:219]
    v_fmac_f32 v250, v248, v200
    v_fmac_f32 v251, v248, v201
    v_fmac_f32 v252, v248, v202
    v_fmac_f32 v253, v248, v203
    v_cvt_pk_bf16_f32 v250, v250, v251
    v_cvt_pk_bf16_f32 v251, v252, v253
    buffer_store_dwordx2 v[250:251], v247, s[28:31], s59 offen
    s_add_u32 s59, s59, 14336
    s_mul_i32 s36, s62, 69632
    s_sub_u32 s36, 4096, s36
    v_add_u32 v245, s36, v245
    s_mul_i32 s37, s62, 45056
    s_sub_u32 s36, 49152, s37
    v_add_u32 v246, s36, v245
    s_add_u32 s37, s37, 57344
    v_subrev_u32 v244, s37, v244
    s_waitcnt vmcnt(7)
    v_mfma_f32_16x16x32_bf16 v[144:147], v[78:81], v[172:175], 0
    v_mfma_f32_16x16x32_bf16 v[148:151], v[82:85], v[172:175], 0
    v_mfma_f32_16x16x32_bf16 v[152:155], v[86:89], v[172:175], 0
    v_mfma_f32_16x16x32_bf16 v[156:159], v[90:93], v[172:175], 0
    s_waitcnt vmcnt(6)
    v_mfma_f32_16x16x32_bf16 v[144:147], v[94:97], v[176:179], v[144:147]
    v_mfma_f32_16x16x32_bf16 v[148:151], v[98:101], v[176:179], v[148:151]
    v_mfma_f32_16x16x32_bf16 v[152:155], v[102:105], v[176:179], v[152:155]
    v_mfma_f32_16x16x32_bf16 v[156:159], v[106:109], v[176:179], v[156:159]
    s_waitcnt vmcnt(5)
    v_mfma_f32_16x16x32_bf16 v[144:147], v[110:113], v[180:183], v[144:147]
    v_mfma_f32_16x16x32_bf16 v[148:151], v[114:117], v[180:183], v[148:151]
    v_mfma_f32_16x16x32_bf16 v[152:155], v[118:121], v[180:183], v[152:155]
    v_mfma_f32_16x16x32_bf16 v[156:159], v[122:125], v[180:183], v[156:159]
    s_waitcnt vmcnt(4)
    v_mfma_f32_16x16x32_bf16 v[144:147], v[126:129], v[184:187], v[144:147]
    v_mfma_f32_16x16x32_bf16 v[148:151], v[130:133], v[184:187], v[148:151]
    v_mfma_f32_16x16x32_bf16 v[152:155], v[134:137], v[184:187], v[152:155]
    v_mfma_f32_16x16x32_bf16 v[156:159], v[138:141], v[184:187], v[156:159]
    s_waitcnt vmcnt(3)
    v_mfma_f32_16x16x32_bf16 v[144:147], v[46:49], v[188:191], v[144:147]
    v_mfma_f32_16x16x32_bf16 v[148:151], v[50:53], v[188:191], v[148:151]
    v_mfma_f32_16x16x32_bf16 v[152:155], v[54:57], v[188:191], v[152:155]
    v_mfma_f32_16x16x32_bf16 v[156:159], v[58:61], v[188:191], v[156:159]
    s_waitcnt vmcnt(2)
    v_mfma_f32_16x16x32_bf16 v[144:147], v[228:231], v[192:195], v[144:147]
    v_mfma_f32_16x16x32_bf16 v[148:151], v[232:235], v[192:195], v[148:151]
    v_mfma_f32_16x16x32_bf16 v[152:155], v[236:239], v[192:195], v[152:155]
    v_mfma_f32_16x16x32_bf16 v[156:159], v[240:243], v[192:195], v[156:159]
    s_waitcnt vmcnt(1)
    v_mfma_f32_16x16x32_bf16 v[144:147], v[26:29], v[196:199], v[144:147]
    v_mfma_f32_16x16x32_bf16 v[148:151], v[30:33], v[196:199], v[148:151]
    v_mfma_f32_16x16x32_bf16 v[152:155], v[34:37], v[196:199], v[152:155]
    v_mfma_f32_16x16x32_bf16 v[156:159], v[38:41], v[196:199], v[156:159]
    s_nop 4
    ds_write_b128 v244, v[144:147] offset:0
    ds_write_b128 v244, v[148:151] offset:1024
    ds_write_b128 v244, v[152:155] offset:2048
    ds_write_b128 v244, v[156:159] offset:3072
    s_waitcnt lgkmcnt(0)
    s_barrier
    ds_read_b128 v[200:203], v245 offset:0
    ds_read_b128 v[204:207], v245 offset:12288
    ds_read_b128 v[208:211], v245 offset:24576
    ds_read_b128 v[212:215], v245 offset:36864
    ds_read_b128 v[216:219], v246 offset:0
    ds_read_b128 v[220:223], v246 offset:12288
    ds_read_b128 v[224:227], v246 offset:24576
    ds_read_b128 v[160:163], v246 offset:36864
    v_lshlrev_b32 v250, 16, v3
    v_and_b32 v251, 0xffff0000, v3
    v_lshlrev_b32 v252, 16, v6
    v_and_b32 v253, 0xffff0000, v6
    s_waitcnt lgkmcnt(6)
    v_pk_add_f32 v[200:201], v[200:201], v[204:205]
    v_pk_add_f32 v[202:203], v[202:203], v[206:207]
    s_waitcnt lgkmcnt(4)
    v_pk_add_f32 v[208:209], v[208:209], v[212:213]
    v_pk_add_f32 v[210:211], v[210:211], v[214:215]
    v_pk_add_f32 v[200:201], v[200:201], v[208:209]
    v_pk_add_f32 v[202:203], v[202:203], v[210:211]
    s_waitcnt lgkmcnt(2)
    v_pk_add_f32 v[216:217], v[216:217], v[220:221]
    v_pk_add_f32 v[218:219], v[218:219], v[222:223]
    s_waitcnt lgkmcnt(0)
    v_pk_add_f32 v[224:225], v[224:225], v[160:161]
    v_pk_add_f32 v[226:227], v[226:227], v[162:163]
    v_pk_add_f32 v[216:217], v[216:217], v[224:225]
    v_pk_add_f32 v[218:219], v[218:219], v[226:227]
    v_pk_add_f32 v[200:201], v[200:201], v[216:217]
    v_pk_add_f32 v[202:203], v[202:203], v[218:219]
    v_fmac_f32 v250, v249, v200
    v_fmac_f32 v251, v249, v201
    v_fmac_f32 v252, v249, v202
    v_fmac_f32 v253, v249, v203
    v_cvt_pk_bf16_f32 v250, v250, v251
    v_cvt_pk_bf16_f32 v251, v252, v253
    buffer_store_dwordx2 v[250:251], v247, s[28:31], s59 offen
    s_waitcnt vmcnt(0)
    s_endpgm
.Lhelp:
    s_lshl1_add_u32 s36, s4, s49
    s_sub_u32 s36, s36, 14
    s_lshl3_add_u32 s36, s36, s3
    s_mul_i32 s36, s36, 6272
    v_min_u32 v6, 48, v1
    v_lshlrev_b32 v6, 7, v6
    buffer_load_dword v30, v6, s[24:27], s36 offen
    s_cmp_eq_u32 s2, 120
    s_cbranch_scc0 .Lhend
    s_cmp_eq_u32 s3, 0
    s_cbranch_scc0 .Lhend
    v_lshlrev_b32 v6, 7, v1
    s_mov_b32 s41, 32772
    buffer_load_dword v0, v6, s[32:35], s41 offen sc1
    s_waitcnt vmcnt(0)
    s_mov_b64 exec, -1
.Lpw_57:
    v_cmp_ne_u32 vcc, v0, v5
    s_and_b64 exec, exec, vcc
    s_cbranch_scc0 .Lpd_58
    buffer_load_dword v0, v6, s[32:35], s41 offen sc1
    s_sub_u32 s48, s48, 1
    s_waitcnt vmcnt(0)
    s_cbranch_scc0 .Lpw_57
    s_mov_b32 s48, 0
.Lpd_58:
    s_mov_b64 exec, -1
    s_mov_b32 s41, 40964
    buffer_load_dword v0, v6, s[32:35], s41 offen sc1
    s_waitcnt vmcnt(0)
    s_mov_b64 exec, -1
.Lpw_59:
    v_cmp_ne_u32 vcc, v0, v5
    s_and_b64 exec, exec, vcc
    s_cbranch_scc0 .Lpd_60
    buffer_load_dword v0, v6, s[32:35], s41 offen sc1
    s_sub_u32 s48, s48, 1
    s_waitcnt vmcnt(0)
    s_cbranch_scc0 .Lpw_59
    s_mov_b32 s48, 0
.Lpd_60:
    s_mov_b64 exec, -1
    s_mov_b32 s41, 262148
    buffer_load_dword v0, v6, s[32:35], s41 offen sc1
    s_waitcnt vmcnt(0)
    s_mov_b64 exec, -1
.Lpw_61:
    v_cmp_ne_u32 vcc, v0, v5
    s_and_b64 exec, exec, vcc
    s_cbranch_scc0 .Lpd_62
    buffer_load_dword v0, v6, s[32:35], s41 offen sc1
    s_sub_u32 s48, s48, 1
    s_waitcnt vmcnt(0)
    s_cbranch_scc0 .Lpw_61
    s_mov_b32 s48, 0
.Lpd_62:
    s_mov_b64 exec, -1
    s_mov_b32 s41, 270340
    buffer_load_dword v0, v6, s[32:35], s41 offen sc1
    s_waitcnt vmcnt(0)
    s_mov_b64 exec, -1
.Lpw_63:
    v_cmp_ne_u32 vcc, v0, v5
    s_and_b64 exec, exec, vcc
    s_cbranch_scc0 .Lpd_64
    buffer_load_dword v0, v6, s[32:35], s41 offen sc1
    s_sub_u32 s48, s48, 1
    s_waitcnt vmcnt(0)
    s_cbranch_scc0 .Lpw_63
    s_mov_b32 s48, 0
.Lpd_64:
    s_mov_b64 exec, -1
    s_mov_b64 exec, 1
    buffer_store_dword v5, off, s[32:35], 0 sc1
    s_mov_b64 exec, -1
.Lhend:
    s_waitcnt vmcnt(0)
    s_endpgm
.Lexit:
    s_endpgm
.section .rodata,"a"
.p2align 6
.amdhsa_kernel sequential_preLN__linear_attn_block__glu_gated_bilinear__prompt_kernel
  .amdhsa_next_free_vgpr 256
  .amdhsa_next_free_sgpr 102
  .amdhsa_accum_offset 256
  .amdhsa_group_segment_fixed_size 0
  .amdhsa_kernarg_size 80
  .amdhsa_user_sgpr_count 2
  .amdhsa_user_sgpr_kernarg_segment_ptr 1
  .amdhsa_system_sgpr_workgroup_id_x 1
.end_amdhsa_kernel
```
